```python
import torch

def _softmax(x, axis=-1):
    return torch.softmax(x, dim=axis)

def _gelu(x):
    return torch.nn.functional.gelu(x, approximate='tanh')

def _silu(x):
    return torch.nn.functional.silu(x)

def _sigmoid(x):
    return torch.sigmoid(x)

def _layernorm(x, axis=-1, eps=1e-05):
    m = x.mean(dim=axis, keepdim=True)
    v = x.var(dim=axis, keepdim=True, unbiased=False)
    return (x - m) / torch.sqrt(v + eps)

def _scatter_add(tgt, idx, src, axis=0):
    return tgt.clone().index_add_(axis, idx, src)

def _segment_sum(src, seg, n):
    out = torch.zeros((n,) + src.shape[1:], dtype=src.dtype)
    return out.index_add_(0, seg, src)

def _pad(x, pw):
    flat = tuple((v for pair in reversed(pw) for v in pair))
    return torch.nn.functional.pad(x, flat)
kernel_name = 'adaLN_cond__gqa_block_cached__dense_activation_silu__decode'

def setup_inputs():

    _w = lambda a: (lambda t: t.to(torch.bfloat16) if t.is_floating_point() else t)(torch.as_tensor(a))

    def _A_setup():
        B, Sq, D = (1, 1, 640)
        Hq, Hkv, Sk, Dh = (32, 32, 16384, 192)
        assert Hq % Hkv == 0, (Hq, Hkv)
        return {'x': _w((lambda *s: torch.randn(*s, dtype=torch.bfloat16) * 0.1)(B, Sq, D)), 'k_cache': _w((lambda *s: torch.randn(*s, dtype=torch.bfloat16) * 0.8)(B, Hkv, Sk, Dh)), 'v_cache': _w((lambda *s: torch.randn(*s, dtype=torch.bfloat16) * 3.2)(B, Hkv, Sk, Dh)), 'wq': _w((lambda *s: torch.randn(*s, dtype=torch.bfloat16) * 0.8)(D, Hq * Dh) * D ** (-0.5)), 'wo': _w((lambda *s: torch.randn(*s, dtype=torch.bfloat16) * 3.2)(Hq * Dh, D) * (Hq * Dh) ** (-0.5))}
    _A_in = _A_setup()

    def _B_setup():
        B, S, D, F = (1, 1, 640, 1536)
        return {'x': _w((lambda *s: torch.randn(*s, dtype=torch.bfloat16) * 0.1)(B, S, D)), 'w1': _w((lambda *s: torch.randn(*s, dtype=torch.bfloat16) * 3.2)(D, F) * D ** (-0.5)), 'w2': _w((lambda *s: torch.randn(*s, dtype=torch.bfloat16) * 3.2)(F, D) * F ** (-0.5))}
    _B_in = _B_setup()
    return {'A_x': _A_in['x'], 'A_k_cache': _A_in['k_cache'], 'A_v_cache': _A_in['v_cache'], 'A_wq': _A_in['wq'], 'A_wo': _A_in['wo'], 'B_x': _B_in['x'], 'B_w1': _B_in['w1'], 'B_w2': _B_in['w2'], 'c': _w((lambda *s: torch.randn(*s, dtype=torch.bfloat16) * 0.2)(1, 640) * 8.0), 'w_mod': _w((lambda *s: torch.randn(*s, dtype=torch.bfloat16) * 0.2)(640, 6 * 640) * 640 ** (-0.5) * 8.0)}

def reference(A_x, A_k_cache, A_v_cache, A_wq, A_wo, B_x, B_w1, B_w2, c, w_mod):

    def _A_ref(x, k_cache, v_cache, wq, wo):
        B, Sq, D = x.shape
        Hq, Dh = (32, 192)
        Hkv = k_cache.shape[1]
        rep = Hq // Hkv
        q = (lambda x, *d: x.permute(*d))((x @ wq).reshape(B, Sq, Hq, Dh), 0, 2, 1, 3)
        k = (lambda x, n, axis: torch.repeat_interleave(x, n, dim=axis))(k_cache, rep, axis=1)
        v = (lambda x, n, axis: torch.repeat_interleave(x, n, dim=axis))(v_cache, rep, axis=1)
        scores = torch.einsum('bhqd,bhkd->bhqk', q, k) * Dh ** (-0.5)
        p = _softmax(scores, axis=-1)
        o = torch.einsum('bhqk,bhkd->bhqd', p, v)
        return (lambda x, *d: x.permute(*d))(o, 0, 2, 1, 3).reshape(B, Sq, Hq * Dh) @ wo

    def _B_ref(x, w1, w2):
        h = torch.einsum('bsd,df->bsf', x, w1)
        h = _silu(h)
        out = torch.einsum('bsf,fd->bsd', h, w2)
        return out
    x = A_x
    mod = (_silu(c) @ w_mod).reshape(c.shape[0], 6, 1, -1)
    sa, ca, ga, sb, cb, gb = (mod[:, 0].clone(), mod[:, 1].clone(), mod[:, 2].clone(), mod[:, 3].clone(), mod[:, 4].clone(), mod[:, 5].clone())
    h = _layernorm(x, axis=-1) * (1 + ca) + sa
    x = x + ga * _A_ref(h, A_k_cache, A_v_cache, A_wq, A_wo)
    h = _layernorm(x, axis=-1) * (1 + cb) + sb
    x = x + gb * _B_ref(h, B_w1, B_w2)
    return x
```

```asm
; @launch grid=(256,1,1) block=(1024,1,1) lds=140288
.amdgcn_target "amdgcn-amd-amdhsa--gfx950"
.text
.globl adaLN_cond__gqa_block_cached__dense_activation_silu__decode_kernel
.p2align 8
.type adaLN_cond__gqa_block_cached__dense_activation_silu__decode_kernel,@function
adaLN_cond__gqa_block_cached__dense_activation_silu__decode_kernel:
    s_cmp_ge_u32 s2, 256
    s_cbranch_scc1 L_exit
    s_load_dwordx16 s[16:31], s[0:1], 0
    s_load_dwordx8 s[32:39], s[0:1], 64
    s_load_dwordx2 s[40:41], s[0:1], 96
    v_lshrrev_b32 v1, 6, v0
    s_nop 0
    v_readfirstlane_b32 s3, v1
    v_and_b32 v0, 63, v0
    s_lshr_b32 s4, s2, 3
    s_lshl_b32 s5, s2, 2
    s_add_u32 s4, s4, s5
    s_and_b32 s4, s4, 31
    s_lshr_b32 s5, s2, 5
    s_mov_b32 s7, 0xffff0000
    s_mov_b32 s42, 0x3fb8aa3b
    s_mov_b32 s43, 0x3d93cd3a
    s_mov_b32 s67, 0
    s_mov_b32 s63, 0
    v_lshrrev_b32 v2, 3, v0
    v_and_b32 v3, 7, v0
    v_mul_u32_u24 v1, 384, v2
    v_lshl_add_u32 v1, v3, 4, v1
    s_mul_i32 s8, s4, 6291456
    s_mov_b32 s46, 6291456
    s_mov_b32 s47, 0x20000
    s_mov_b32 s50, 6291456
    s_mov_b32 s51, 0x20000
    s_mov_b32 s55, 0x20000
    s_mov_b32 s59, 0x20000
    s_mul_i32 s9, s4, 1152
    s_add_u32 s9, s9, 4096
    v_mov_b32 v4, 0
    v_mov_b32 v5, 0
    v_mov_b32 v6, 0
    v_mov_b32 v7, 0
    s_cmp_lt_u32 s5, 3
    s_cselect_b32 s10, 16, 112
    v_mov_b32 v8, s10
    v_mov_b32 v9, 16
    s_mov_b64 exec, 1
    ds_write_b128 v4, v[4:7] offset:512
    ds_write_b128 v4, v[4:7] offset:528
    ds_write_b64 v4, v[8:9] offset:544
    s_mov_b64 exec, -1
    v_mov_b32 v10, -1
    v_mov_b32 v11, -1
    v_lshlrev_b32 v12, 3, v0
    v_lshl_add_u32 v12, s3, 9, v12
    v_add_u32 v12, 132096, v12
    ds_write_b64 v12, v[10:11]
    s_waitcnt lgkmcnt(0)
    s_add_u32 s44, s18, s8
    s_addc_u32 s45, s19, 0
    s_add_u32 s48, s20, s8
    s_addc_u32 s49, s21, 0
    s_add_u32 s60, s40, s9
    s_addc_u32 s61, s41, 0
    s_load_dword s6, s[40:41], 0
    s_mov_b32 s12, 0xff00ff00
    s_mov_b32 s13, 0xff00ff00
    s_cmp_lt_u32 s5, 3
    s_cbranch_scc1 L_qtile
    s_lshr_b32 s9, s2, 3
    s_and_b32 s8, s9, 3
    s_cmp_eq_u32 s8, 3
    s_cbranch_scc1 L_tilebar
    s_sub_u32 s9, s5, 3
    s_mul_i32 s9, s9, 3
    s_add_u32 s9, s9, s8
    s_cmp_ge_u32 s9, 10
    s_cbranch_scc1 L_tilebar
L_modtile:
    s_lshl_b32 s9, s9, 3
    s_and_b32 s8, s2, 7
    s_add_u32 s9, s9, s8
    s_cmp_ge_u32 s3, 10
    s_cbranch_scc1 L_poison
    s_lshr_b32 s11, s9, 2
    s_and_b32 s15, s9, 3
    s_lshl_b32 s14, s11, 7
    s_mul_i32 s8, s15, 1228800
    s_add_u32 s14, s14, s8
    s_add_u32 s52, s34, s14
    s_addc_u32 s53, s35, 0
    s_sub_u32 s54, 4915200, s14
    s_mul_i32 s14, s15, 320
    s_lshl_b32 s8, s3, 5
    s_add_u32 s14, s14, s8
    v_lshl_add_u32 v7, v2, 1, s14
    global_load_ushort v24, v7, s[32:33] offset:0
    global_load_ushort v25, v7, s[32:33] offset:16
    s_mul_i32 s10, s3, 122880
    v_mul_u32_u24 v4, 7680, v2
    v_lshl_add_u32 v4, v3, 4, v4
    buffer_load_dwordx4 v[48:51], v4, s[52:55], s10 offen nt
    s_add_u32 s10, s10, 61440
    buffer_load_dwordx4 v[52:55], v4, s[52:55], s10 offen nt
    v_lshl_add_u32 v5, v3, 3, v2
    s_lshl_b32 s8, s3, 8
    v_lshl_add_u32 v5, v5, 2, s8
    v_mov_b32 v40, 0
    v_mov_b32 v41, 0
    v_mov_b32 v42, 0
    v_mov_b32 v43, 0
    v_mov_b32 v44, 0
    v_mov_b32 v45, 0
    v_mov_b32 v46, 0
    v_mov_b32 v47, 0
    s_mul_i32 s14, s15, 10240
    s_lshl_b32 s8, s11, 9
    s_add_u32 s14, s14, s8
    s_add_u32 s14, s14, 131072
    v_lshl_add_u32 v6, v0, 3, s14
    s_waitcnt vmcnt(2)
    v_lshlrev_b32 v24, 16, v24
    v_mul_f32 v30, s42, v24
    v_exp_f32 v30, -v30
    s_nop 0
    v_add_f32 v30, 1.0, v30
    v_rcp_f32 v30, v30
    s_nop 0
    v_mul_f32 v24, v24, v30
    v_cvt_pk_bf16_f32 v24, v24, v24
    v_and_b32 v24, s7, v24
    v_lshrrev_b32 v30, 16, v24
    v_lshlrev_b32 v25, 16, v25
    v_mul_f32 v31, s42, v25
    v_exp_f32 v31, -v31
    s_nop 0
    v_add_f32 v31, 1.0, v31
    v_rcp_f32 v31, v31
    s_nop 0
    v_mul_f32 v25, v25, v31
    v_cvt_pk_bf16_f32 v25, v25, v25
    v_and_b32 v25, s7, v25
    v_lshrrev_b32 v31, 16, v25
    s_waitcnt vmcnt(0)
    v_dot2c_f32_bf16 v40, v48, v30
    v_dot2c_f32_bf16 v41, v48, v24
    v_dot2c_f32_bf16 v42, v49, v30
    v_dot2c_f32_bf16 v43, v49, v24
    v_dot2c_f32_bf16 v44, v50, v30
    v_dot2c_f32_bf16 v45, v50, v24
    v_dot2c_f32_bf16 v46, v51, v30
    v_dot2c_f32_bf16 v47, v51, v24
    v_dot2c_f32_bf16 v40, v52, v31
    v_dot2c_f32_bf16 v41, v52, v25
    v_dot2c_f32_bf16 v42, v53, v31
    v_dot2c_f32_bf16 v43, v53, v25
    v_dot2c_f32_bf16 v44, v54, v31
    v_dot2c_f32_bf16 v45, v54, v25
    v_dot2c_f32_bf16 v46, v55, v31
    v_dot2c_f32_bf16 v47, v55, v25
    v_permlane32_swap_b32 v40, v44
    v_permlane32_swap_b32 v41, v45
    v_permlane32_swap_b32 v42, v46
    v_permlane32_swap_b32 v43, v47
    v_add_f32 v40, v40, v44
    v_add_f32 v41, v41, v45
    v_add_f32 v42, v42, v46
    v_add_f32 v43, v43, v47
    s_nop 0
    v_permlane16_swap_b32 v40, v42
    v_permlane16_swap_b32 v41, v43
    v_add_f32 v40, v40, v42
    v_add_f32 v41, v41, v43
    s_nop 0
    v_add_f32_dpp v40, v40, v40 row_ror:8 row_mask:0xf bank_mask:0xf
    v_add_f32_dpp v41, v41, v41 row_ror:8 row_mask:0xf bank_mask:0xf
    v_cndmask_b32 v40, v40, v41, s[12:13]
    ds_write_b32 v5, v40 offset:6912
L_modjoin:
    s_waitcnt vmcnt(0) lgkmcnt(0)
    s_barrier
    s_cmp_lg_u32 s3, 0
    s_cbranch_scc1 L_tilebar
    v_lshlrev_b32 v5, 2, v0
    v_add_u32 v5, 6912, v5
    ds_read2st64_b32 v[24:25], v5 offset0:0 offset1:1
    ds_read2st64_b32 v[26:27], v5 offset0:2 offset1:3
    ds_read2st64_b32 v[28:29], v5 offset0:4 offset1:5
    ds_read2st64_b32 v[30:31], v5 offset0:6 offset1:7
    ds_read2st64_b32 v[32:33], v5 offset0:8 offset1:9
    s_waitcnt lgkmcnt(4)
    v_add_f32 v24, v24, v25
    s_waitcnt lgkmcnt(3)
    v_add_f32 v26, v26, v27
    v_add_f32 v24, v24, v26
    s_waitcnt lgkmcnt(2)
    v_add_f32 v28, v28, v29
    s_waitcnt lgkmcnt(1)
    v_add_f32 v30, v30, v31
    v_add_f32 v28, v28, v30
    s_waitcnt lgkmcnt(0)
    v_add_f32 v32, v32, v33
    v_add_f32 v24, v24, v28
    v_add_f32 v24, v24, v32
    s_add_u32 s8, s6, 0x9e3779b9
    v_mov_b32 v25, s8
    global_store_dwordx2 v6, v[24:25], s[40:41] sc1
    s_branch L_tilebar
L_poison:
    s_mul_i32 s14, s9, 6
    s_add_u32 s14, s14, s3
    s_lshl_b32 s14, s14, 10
    s_add_u32 s14, s14, 1038336
    v_lshl_add_u32 v6, v0, 4, s14
    v_mov_b32 v88, -1
    v_mov_b32 v89, -1
    v_mov_b32 v90, -1
    v_mov_b32 v91, -1
    global_store_dwordx4 v6, v[88:91], s[40:41] sc1
    s_cmp_lg_u32 s3, 15
    s_cbranch_scc1 L_modjoin
    s_cmp_ge_u32 s9, 40
    s_cbranch_scc1 L_modjoin
    s_mul_i32 s14, s9, 1152
    s_add_u32 s14, s14, 4096
    v_mov_b32 v6, s14
    v_mov_b32 v8, 0
    s_mov_b64 exec, 1
    global_store_dword v6, v8, s[40:41] sc1
    s_mov_b64 exec, -1
    s_branch L_modjoin
L_qtile:
    s_mul_i32 s8, s4, 384
    s_lshl_b32 s9, s5, 7
    s_add_u32 s8, s8, s9
    s_add_u32 s52, s22, s8
    s_addc_u32 s53, s23, 0
    s_sub_u32 s54, 7864320, s8
    v_lshlrev_b32 v5, 2, v0
    s_mul_i32 s14, s3, 40
    v_add_u32 v8, s14, v3
    v_lshlrev_b32 v7, 1, v8
    s_mul_i32 s10, s3, 491520
    v_mul_u32_u24 v4, 12288, v2
    v_lshl_add_u32 v4, v3, 4, v4
    buffer_load_dwordx4 v[48:51], v4, s[52:55], s10 offen nt
    s_add_u32 s10, s10, 98304
    buffer_load_dwordx4 v[52:55], v4, s[52:55], s10 offen nt
    s_add_u32 s10, s10, 98304
    buffer_load_dwordx4 v[56:59], v4, s[52:55], s10 offen nt
    s_add_u32 s10, s10, 98304
    buffer_load_dwordx4 v[60:63], v4, s[52:55], s10 offen nt
    s_add_u32 s10, s10, 98304
    buffer_load_dwordx4 v[64:67], v4, s[52:55], s10 offen nt
    s_barrier
    global_load_dword v70, v5, s[16:17] offset:0
    global_load_dword v71, v5, s[16:17] offset:256
    global_load_dword v72, v5, s[16:17] offset:512
    global_load_dword v73, v5, s[16:17] offset:768
    global_load_dword v74, v5, s[16:17] offset:1024
    global_load_ushort v30, v7, s[16:17] offset:0
    global_load_ushort v31, v7, s[16:17] offset:16
    global_load_ushort v32, v7, s[16:17] offset:32
    global_load_ushort v33, v7, s[16:17] offset:48
    global_load_ushort v34, v7, s[16:17] offset:64
    v_lshlrev_b32 v8, 3, v8
    v_and_b32 v9, 3, v2
    v_mul_u32_u24 v9, 10240, v9
    v_add_u32 v8, v8, v9
    v_lshrrev_b32 v9, 5, v0
    v_mul_u32_u24 v9, 5120, v9
    v_add_u32 v8, v8, v9
    v_add_u32 v8, 131072, v8
    v_lshlrev_b32 v9, 2, v2
    v_lshl_add_u32 v5, v3, 3, v2
    s_lshl_b32 s8, s3, 8
    v_lshl_add_u32 v5, v5, 2, s8
    v_mov_b32 v40, 0
    v_mov_b32 v41, 0
    v_mov_b32 v42, 0
    v_mov_b32 v43, 0
    v_mov_b32 v44, 0
    v_mov_b32 v45, 0
    v_mov_b32 v46, 0
    v_mov_b32 v47, 0
    v_lshrrev_b32 v10, 1, v0
    v_mul_u32_u24 v11, 43, v10
    v_lshrrev_b32 v11, 7, v11
    v_add_u32 v11, v11, v10
    v_lshlrev_b32 v11, 2, v11
    v_lshlrev_b32 v10, 4, v10
    v_add_u32 v10, 12, v10
    v_and_b32 v12, 1, v0
    v_cmp_eq_u32 s[14:15], 1, v12
    s_mul_i32 s8, s4, 768
    s_lshl_b32 s9, s5, 8
    s_add_u32 s8, s8, s9
    s_add_u32 s8, s8, 196608
    v_cndmask_b32 v10, v11, v10, s[14:15]
    v_add_u32 v10, s8, v10
    s_waitcnt vmcnt(0)
    v_lshlrev_b32 v76, 16, v70
    v_and_b32 v77, s7, v70
    v_lshlrev_b32 v78, 16, v71
    v_and_b32 v79, s7, v71
    v_lshlrev_b32 v80, 16, v72
    v_and_b32 v81, s7, v72
    v_lshlrev_b32 v82, 16, v73
    v_and_b32 v83, s7, v73
    v_lshlrev_b32 v84, 16, v74
    v_and_b32 v85, s7, v74
    v_add_f32 v70, v76, v77
    v_add_f32 v70, v70, v78
    v_add_f32 v70, v70, v79
    v_add_f32 v70, v70, v80
    v_add_f32 v70, v70, v81
    v_add_f32 v70, v70, v82
    v_add_f32 v70, v70, v83
    v_add_f32 v70, v70, v84
    v_add_f32 v70, v70, v85
    s_nop 1
    v_add_f32_dpp v70, v70, v70 quad_perm:[1,0,3,2] row_mask:0xf bank_mask:0xf
    s_nop 1
    v_add_f32_dpp v70, v70, v70 quad_perm:[2,3,0,1] row_mask:0xf bank_mask:0xf
    s_nop 1
    v_add_f32_dpp v70, v70, v70 row_half_mirror row_mask:0xf bank_mask:0xf
    s_nop 1
    v_add_f32_dpp v70, v70, v70 row_mirror row_mask:0xf bank_mask:0xf
    v_mov_b32 v71, v70
    s_nop 1
    v_permlane16_swap_b32 v70, v71
    v_add_f32 v70, v70, v71
    v_mov_b32 v71, v70
    s_nop 1
    v_permlane32_swap_b32 v70, v71
    v_add_f32 v70, v70, v71
    v_mul_f32 v70, 0x3acccccd, v70
    v_mov_b32 v72, 0
    v_sub_f32 v76, v76, v70
    v_fmac_f32 v72, v76, v76
    v_sub_f32 v77, v77, v70
    v_fmac_f32 v72, v77, v77
    v_sub_f32 v78, v78, v70
    v_fmac_f32 v72, v78, v78
    v_sub_f32 v79, v79, v70
    v_fmac_f32 v72, v79, v79
    v_sub_f32 v80, v80, v70
    v_fmac_f32 v72, v80, v80
    v_sub_f32 v81, v81, v70
    v_fmac_f32 v72, v81, v81
    v_sub_f32 v82, v82, v70
    v_fmac_f32 v72, v82, v82
    v_sub_f32 v83, v83, v70
    v_fmac_f32 v72, v83, v83
    v_sub_f32 v84, v84, v70
    v_fmac_f32 v72, v84, v84
    v_sub_f32 v85, v85, v70
    v_fmac_f32 v72, v85, v85
    s_nop 1
    v_add_f32_dpp v72, v72, v72 quad_perm:[1,0,3,2] row_mask:0xf bank_mask:0xf
    s_nop 1
    v_add_f32_dpp v72, v72, v72 quad_perm:[2,3,0,1] row_mask:0xf bank_mask:0xf
    s_nop 1
    v_add_f32_dpp v72, v72, v72 row_half_mirror row_mask:0xf bank_mask:0xf
    s_nop 1
    v_add_f32_dpp v72, v72, v72 row_mirror row_mask:0xf bank_mask:0xf
    v_mov_b32 v71, v72
    s_nop 1
    v_permlane16_swap_b32 v72, v71
    v_add_f32 v72, v72, v71
    v_mov_b32 v71, v72
    s_nop 1
    v_permlane32_swap_b32 v72, v71
    v_add_f32 v72, v72, v71
    v_mul_f32 v72, 0x3acccccd, v72
    v_cvt_pk_bf16_f32 v70, v70, v70
    v_and_b32 v70, s7, v70
    v_cvt_pk_bf16_f32 v72, v72, v72
    v_and_b32 v72, s7, v72
    v_add_f32 v72, 0x3727c5ac, v72
    v_cvt_pk_bf16_f32 v72, v72, v72
    v_and_b32 v72, s7, v72
    v_sqrt_f32 v72, v72
    s_nop 0
    v_cvt_pk_bf16_f32 v72, v72, v72
    v_and_b32 v72, s7, v72
    v_rcp_f32 v72, v72
    v_lshlrev_b32 v30, 16, v30
    v_sub_f32 v30, v30, v70
    v_cvt_pk_bf16_f32 v30, v30, v30
    v_and_b32 v30, s7, v30
    v_mul_f32 v30, v30, v72
    v_cvt_pk_bf16_f32 v30, v30, v30
    v_and_b32 v30, s7, v30
    v_lshlrev_b32 v31, 16, v31
    v_sub_f32 v31, v31, v70
    v_cvt_pk_bf16_f32 v31, v31, v31
    v_and_b32 v31, s7, v31
    v_mul_f32 v31, v31, v72
    v_cvt_pk_bf16_f32 v31, v31, v31
    v_and_b32 v31, s7, v31
    v_lshlrev_b32 v32, 16, v32
    v_sub_f32 v32, v32, v70
    v_cvt_pk_bf16_f32 v32, v32, v32
    v_and_b32 v32, s7, v32
    v_mul_f32 v32, v32, v72
    v_cvt_pk_bf16_f32 v32, v32, v32
    v_and_b32 v32, s7, v32
    v_lshlrev_b32 v33, 16, v33
    v_sub_f32 v33, v33, v70
    v_cvt_pk_bf16_f32 v33, v33, v33
    v_and_b32 v33, s7, v33
    v_mul_f32 v33, v33, v72
    v_cvt_pk_bf16_f32 v33, v33, v33
    v_and_b32 v33, s7, v33
    v_lshlrev_b32 v34, 16, v34
    v_sub_f32 v34, v34, v70
    v_cvt_pk_bf16_f32 v34, v34, v34
    v_and_b32 v34, s7, v34
    v_mul_f32 v34, v34, v72
    v_cvt_pk_bf16_f32 v34, v34, v34
    v_and_b32 v34, s7, v34
    s_waitcnt lgkmcnt(0)
    s_add_u32 s11, s6, 0x9e3779b9
GM_1:
    global_load_dwordx2 v[88:89], v8, s[40:41] offset:0 sc1
    global_load_dwordx2 v[90:91], v8, s[40:41] offset:64 sc1
    global_load_dwordx2 v[92:93], v8, s[40:41] offset:128 sc1
    global_load_dwordx2 v[94:95], v8, s[40:41] offset:192 sc1
    global_load_dwordx2 v[96:97], v8, s[40:41] offset:256 sc1
    s_waitcnt vmcnt(0)
    v_xor_b32 v70, s11, v89
    v_bitop3_b32 v70, v70, v91, s11 bitop3:0xf6
    v_bitop3_b32 v70, v70, v93, s11 bitop3:0xf6
    v_bitop3_b32 v70, v70, v95, s11 bitop3:0xf6
    v_bitop3_b32 v70, v70, v97, s11 bitop3:0xf6
    v_cmp_ne_u32 vcc, 0, v70
    s_cbranch_vccz GD_2
    s_add_u32 s67, s67, 1
    s_cmp_gt_u32 s67, 2000000
    s_cbranch_scc1 L_end
    s_sleep 2
    s_branch GM_1
GD_2:
    v_add_f32_dpp v88, v88, v88 row_ror:8 row_mask:0xf bank_mask:0xf
    v_add_f32_dpp v90, v90, v90 row_ror:8 row_mask:0xf bank_mask:0xf
    v_add_f32_dpp v92, v92, v92 row_ror:8 row_mask:0xf bank_mask:0xf
    v_add_f32_dpp v94, v94, v94 row_ror:8 row_mask:0xf bank_mask:0xf
    v_add_f32_dpp v96, v96, v96 row_ror:8 row_mask:0xf bank_mask:0xf
    v_mov_b32 v89, v88
    v_mov_b32 v91, v90
    v_mov_b32 v93, v92
    v_mov_b32 v95, v94
    v_mov_b32 v97, v96
    v_permlane16_swap_b32 v88, v89
    v_permlane16_swap_b32 v90, v91
    v_permlane16_swap_b32 v92, v93
    v_permlane16_swap_b32 v94, v95
    v_permlane16_swap_b32 v96, v97
    v_add_f32 v88, v88, v89
    v_add_f32 v90, v90, v91
    v_add_f32 v92, v92, v93
    v_add_f32 v94, v94, v95
    v_add_f32 v96, v96, v97
    v_cvt_pk_bf16_f32 v88, v88, v88
    v_and_b32 v88, s7, v88
    v_cvt_pk_bf16_f32 v90, v90, v90
    v_and_b32 v90, s7, v90
    v_cvt_pk_bf16_f32 v92, v92, v92
    v_and_b32 v92, s7, v92
    v_cvt_pk_bf16_f32 v94, v94, v94
    v_and_b32 v94, s7, v94
    v_cvt_pk_bf16_f32 v96, v96, v96
    v_and_b32 v96, s7, v96
    v_mov_b32 v89, v88
    v_mov_b32 v91, v90
    v_mov_b32 v93, v92
    v_mov_b32 v95, v94
    v_mov_b32 v97, v96
    v_permlane32_swap_b32 v88, v89
    v_permlane32_swap_b32 v90, v91
    v_permlane32_swap_b32 v92, v93
    v_permlane32_swap_b32 v94, v95
    v_permlane32_swap_b32 v96, v97
    v_add_f32 v89, 1.0, v89
    v_add_f32 v91, 1.0, v91
    v_add_f32 v93, 1.0, v93
    v_add_f32 v95, 1.0, v95
    v_add_f32 v97, 1.0, v97
    v_cvt_pk_bf16_f32 v89, v89, v89
    v_and_b32 v89, s7, v89
    v_cvt_pk_bf16_f32 v91, v91, v91
    v_and_b32 v91, s7, v91
    v_cvt_pk_bf16_f32 v93, v93, v93
    v_and_b32 v93, s7, v93
    v_cvt_pk_bf16_f32 v95, v95, v95
    v_and_b32 v95, s7, v95
    v_cvt_pk_bf16_f32 v97, v97, v97
    v_and_b32 v97, s7, v97
    v_mul_f32 v89, v30, v89
    v_mul_f32 v91, v31, v91
    v_mul_f32 v93, v32, v93
    v_mul_f32 v95, v33, v95
    v_mul_f32 v97, v34, v97
    v_cvt_pk_bf16_f32 v89, v89, v89
    v_and_b32 v89, s7, v89
    v_cvt_pk_bf16_f32 v91, v91, v91
    v_and_b32 v91, s7, v91
    v_cvt_pk_bf16_f32 v93, v93, v93
    v_and_b32 v93, s7, v93
    v_cvt_pk_bf16_f32 v95, v95, v95
    v_and_b32 v95, s7, v95
    v_cvt_pk_bf16_f32 v97, v97, v97
    v_and_b32 v97, s7, v97
    v_add_f32 v89, v89, v88
    v_add_f32 v91, v91, v90
    v_add_f32 v93, v93, v92
    v_add_f32 v95, v95, v94
    v_add_f32 v97, v97, v96
    v_cvt_pk_bf16_f32 v89, v89, 0
    v_cvt_pk_bf16_f32 v91, v91, 0
    v_cvt_pk_bf16_f32 v93, v93, 0
    v_cvt_pk_bf16_f32 v95, v95, 0
    v_cvt_pk_bf16_f32 v97, v97, 0
    ds_bpermute_b32 v30, v9, v89
    ds_bpermute_b32 v31, v9, v91
    ds_bpermute_b32 v32, v9, v93
    ds_bpermute_b32 v33, v9, v95
    ds_bpermute_b32 v34, v9, v97
    s_waitcnt lgkmcnt(4)
    v_lshlrev_b32 v24, 16, v30
    s_waitcnt lgkmcnt(3)
    v_lshlrev_b32 v25, 16, v31
    s_waitcnt lgkmcnt(2)
    v_lshlrev_b32 v26, 16, v32
    s_waitcnt lgkmcnt(1)
    v_lshlrev_b32 v27, 16, v33
    s_waitcnt lgkmcnt(0)
    v_lshlrev_b32 v28, 16, v34
    v_dot2c_f32_bf16 v40, v48, v30
    v_dot2c_f32_bf16 v41, v48, v24
    v_dot2c_f32_bf16 v42, v49, v30
    v_dot2c_f32_bf16 v43, v49, v24
    v_dot2c_f32_bf16 v44, v50, v30
    v_dot2c_f32_bf16 v45, v50, v24
    v_dot2c_f32_bf16 v46, v51, v30
    v_dot2c_f32_bf16 v47, v51, v24
    v_dot2c_f32_bf16 v40, v52, v31
    v_dot2c_f32_bf16 v41, v52, v25
    v_dot2c_f32_bf16 v42, v53, v31
    v_dot2c_f32_bf16 v43, v53, v25
    v_dot2c_f32_bf16 v44, v54, v31
    v_dot2c_f32_bf16 v45, v54, v25
    v_dot2c_f32_bf16 v46, v55, v31
    v_dot2c_f32_bf16 v47, v55, v25
    v_dot2c_f32_bf16 v40, v56, v32
    v_dot2c_f32_bf16 v41, v56, v26
    v_dot2c_f32_bf16 v42, v57, v32
    v_dot2c_f32_bf16 v43, v57, v26
    v_dot2c_f32_bf16 v44, v58, v32
    v_dot2c_f32_bf16 v45, v58, v26
    v_dot2c_f32_bf16 v46, v59, v32
    v_dot2c_f32_bf16 v47, v59, v26
    v_dot2c_f32_bf16 v40, v60, v33
    v_dot2c_f32_bf16 v41, v60, v27
    v_dot2c_f32_bf16 v42, v61, v33
    v_dot2c_f32_bf16 v43, v61, v27
    v_dot2c_f32_bf16 v44, v62, v33
    v_dot2c_f32_bf16 v45, v62, v27
    v_dot2c_f32_bf16 v46, v63, v33
    v_dot2c_f32_bf16 v47, v63, v27
    v_dot2c_f32_bf16 v40, v64, v34
    v_dot2c_f32_bf16 v41, v64, v28
    v_dot2c_f32_bf16 v42, v65, v34
    v_dot2c_f32_bf16 v43, v65, v28
    v_dot2c_f32_bf16 v44, v66, v34
    v_dot2c_f32_bf16 v45, v66, v28
    v_dot2c_f32_bf16 v46, v67, v34
    v_dot2c_f32_bf16 v47, v67, v28
    v_permlane32_swap_b32 v40, v44
    v_permlane32_swap_b32 v41, v45
    v_permlane32_swap_b32 v42, v46
    v_permlane32_swap_b32 v43, v47
    v_add_f32 v40, v40, v44
    v_add_f32 v41, v41, v45
    v_add_f32 v42, v42, v46
    v_add_f32 v43, v43, v47
    s_nop 0
    v_permlane16_swap_b32 v40, v42
    v_permlane16_swap_b32 v41, v43
    v_add_f32 v40, v40, v42
    v_add_f32 v41, v41, v43
    s_nop 0
    v_add_f32_dpp v40, v40, v40 row_ror:8 row_mask:0xf bank_mask:0xf
    v_add_f32_dpp v41, v41, v41 row_ror:8 row_mask:0xf bank_mask:0xf
    v_cndmask_b32 v40, v40, v41, s[12:13]
    ds_write_b32 v5, v40 offset:6912
    s_waitcnt vmcnt(0) lgkmcnt(0)
    s_barrier
    s_cmp_lg_u32 s3, 0
    s_cbranch_scc1 L_tilebar
    v_lshlrev_b32 v5, 2, v0
    v_add_u32 v5, 6912, v5
    ds_read2st64_b32 v[24:25], v5 offset0:0 offset1:1
    ds_read2st64_b32 v[26:27], v5 offset0:2 offset1:3
    ds_read2st64_b32 v[28:29], v5 offset0:4 offset1:5
    ds_read2st64_b32 v[30:31], v5 offset0:6 offset1:7
    ds_read2st64_b32 v[32:33], v5 offset0:8 offset1:9
    ds_read2st64_b32 v[34:35], v5 offset0:10 offset1:11
    ds_read2st64_b32 v[36:37], v5 offset0:12 offset1:13
    ds_read2st64_b32 v[38:39], v5 offset0:14 offset1:15
    s_waitcnt lgkmcnt(7)
    v_add_f32 v24, v24, v25
    s_waitcnt lgkmcnt(6)
    v_add_f32 v26, v26, v27
    v_add_f32 v24, v24, v26
    s_waitcnt lgkmcnt(5)
    v_add_f32 v28, v28, v29
    s_waitcnt lgkmcnt(4)
    v_add_f32 v30, v30, v31
    v_add_f32 v28, v28, v30
    s_waitcnt lgkmcnt(3)
    v_add_f32 v32, v32, v33
    s_waitcnt lgkmcnt(2)
    v_add_f32 v34, v34, v35
    v_add_f32 v32, v32, v34
    s_waitcnt lgkmcnt(1)
    v_add_f32 v36, v36, v37
    s_waitcnt lgkmcnt(0)
    v_add_f32 v38, v38, v39
    v_add_f32 v36, v36, v38
    v_add_f32 v24, v24, v28
    v_add_f32 v32, v32, v36
    v_add_f32 v24, v24, v32
    s_nop 1
    v_mov_b32_dpp v25, v24 quad_perm:[1,0,3,2] row_mask:0xf bank_mask:0xf
    v_mov_b32 v26, s11
    v_cvt_pk_bf16_f32 v24, v24, v25
    v_cndmask_b32 v24, v24, v26, s[14:15]
    s_mov_b32 exec_lo, 0x557fffff
    s_mov_b32 exec_hi, 0x55555555
    global_store_dword v10, v24, s[40:41] sc1
    s_mov_b64 exec, -1
L_tilebar:
    s_barrier
L_roles:
    s_cmp_lt_u32 s3, 4
    s_cbranch_scc1 L_chain
    s_sub_u32 s9, s3, 4
    v_lshlrev_b32 v8, 2, v2
    v_add_u32 v8, 132096, v8
    s_cmp_ge_u32 s5, 3
    s_cbranch_scc1 L_fill
    s_cmp_ge_u32 s3, 12
    s_cbranch_scc1 L_retired
    s_mul_i32 s64, s5, 614400
    s_mov_b32 s65, 200
    s_mul_i32 s62, s9, 3072
    s_add_u32 s62, s62, s64
    s_lshl_b32 s74, s9, 5
    s_add_u32 s75, s74, 256
    buffer_load_dwordx4 v[48:51], v1, s[44:47], s62 offen offset:0 nt
    buffer_load_dwordx4 v[52:55], v1, s[44:47], s62 offen offset:128 nt
    buffer_load_dwordx4 v[56:59], v1, s[44:47], s62 offen offset:256 nt
    s_add_u32 s62, s62, 24576
    buffer_load_dwordx4 v[60:63], v1, s[44:47], s62 offen offset:0 nt
    buffer_load_dwordx4 v[64:67], v1, s[44:47], s62 offen offset:128 nt
    buffer_load_dwordx4 v[68:71], v1, s[44:47], s62 offen offset:256 nt
    s_branch L_filled
L_fill:
    s_mul_i32 s64, s5, 712704
    s_add_u32 s64, s64, -294912
    s_mul_i32 s8, s5, 712704
    s_add_u32 s8, s8, -294912
    s_movk_i32 s65, 232
    s_cmp_ge_u32 s5, 5
    s_cselect_b32 s64, s8, s64
    s_cselect_b32 s65, 232, s65
    s_cmp_eq_u32 s5, 7
    s_cselect_b32 s65, 220, s65
    s_mul_i32 s62, s9, 3072
    s_add_u32 s62, s62, s64
    s_lshl_b32 s74, s9, 5
    v_add_u32 v9, s74, v8
    s_add_u32 s74, s74, 3072
    s_add_u32 s75, s74, 256
    s_mul_i32 s11, s9, 6144
    buffer_load_dwordx4 v[48:51], v1, s[44:47], s62 offen offset:0 nt
    buffer_load_dwordx4 v[52:55], v1, s[44:47], s62 offen offset:128 nt
    buffer_load_dwordx4 v[56:59], v1, s[44:47], s62 offen offset:256 nt
    s_add_u32 s62, s62, 36864
    buffer_load_dwordx4 v[60:63], v1, s[44:47], s62 offen offset:0 nt
    s_waitcnt vmcnt(3)
    buffer_load_dwordx4 v[64:67], v1, s[44:47], s62 offen offset:128 nt
    s_waitcnt vmcnt(3)
    buffer_load_dwordx4 v[68:71], v1, s[44:47], s62 offen offset:256 nt
    s_add_u32 s62, s62, 36864
    s_waitcnt vmcnt(3)
    buffer_load_dwordx4 v[72:75], v1, s[44:47], s62 offen offset:0 nt
    s_waitcnt vmcnt(3)
    buffer_load_dwordx4 v[76:79], v1, s[44:47], s62 offen offset:128 nt
    s_waitcnt vmcnt(3)
    buffer_load_dwordx4 v[80:83], v1, s[44:47], s62 offen offset:256 nt
    s_add_u32 s62, s62, 36864
    s_waitcnt vmcnt(3)
    buffer_load_dwordx4 v[84:87], v1, s[44:47], s62 offen offset:0 nt
    s_waitcnt vmcnt(3)
    buffer_load_dwordx4 v[88:91], v1, s[44:47], s62 offen offset:128 nt
    s_waitcnt vmcnt(3)
    buffer_load_dwordx4 v[92:95], v1, s[44:47], s62 offen offset:256 nt
    s_add_u32 s62, s62, 36864
    s_waitcnt vmcnt(3)
    buffer_load_dwordx4 v[96:99], v1, s[44:47], s62 offen offset:0 nt
    s_waitcnt vmcnt(3)
    buffer_load_dwordx4 v[100:103], v1, s[44:47], s62 offen offset:128 nt
    s_waitcnt vmcnt(3)
    buffer_load_dwordx4 v[104:107], v1, s[44:47], s62 offen offset:256 nt
    s_add_u32 s62, s62, 36864
    s_waitcnt vmcnt(3)
    buffer_load_dwordx4 v[108:111], v1, s[44:47], s62 offen offset:0 nt
    s_waitcnt vmcnt(3)
    buffer_load_dwordx4 v[112:115], v1, s[44:47], s62 offen offset:128 nt
    s_waitcnt vmcnt(3)
    buffer_load_dwordx4 v[116:119], v1, s[44:47], s62 offen offset:256 nt
    s_add_u32 s62, s62, 36864
    s_waitcnt vmcnt(3)
    s_add_u32 m0, s11, 16384
    s_nop 0
    buffer_load_dwordx4 v1, s[44:47], s62 offen offset:0 nt lds
    s_waitcnt vmcnt(3)
    s_add_u32 m0, s11, 17280
    s_nop 0
    buffer_load_dwordx4 v1, s[44:47], s62 offen offset:128 nt lds
    s_waitcnt vmcnt(3)
    s_add_u32 m0, s11, 18176
    s_nop 0
    buffer_load_dwordx4 v1, s[44:47], s62 offen offset:256 nt lds
    s_add_u32 s62, s62, 36864
    s_waitcnt vmcnt(3)
    s_add_u32 m0, s11, 19456
    s_nop 0
    buffer_load_dwordx4 v1, s[44:47], s62 offen offset:0 nt lds
    s_waitcnt vmcnt(3)
    s_add_u32 m0, s11, 20352
    s_nop 0
    buffer_load_dwordx4 v1, s[44:47], s62 offen offset:128 nt lds
    s_waitcnt vmcnt(3)
    s_add_u32 m0, s11, 21248
    s_nop 0
    buffer_load_dwordx4 v1, s[44:47], s62 offen offset:256 nt lds
    s_add_u32 s62, s62, 36864
L_filled:
    v_mov_b32 v4, 0
LW_3:
    ds_read_b32 v5, v4 offset:512
    s_waitcnt lgkmcnt(0)
    v_readfirstlane_b32 s8, v5
    s_nop 0
    s_cmp_ge_u32 s8, 3
    s_cbranch_scc1 L_qready
    s_add_u32 s67, s67, 1
    s_cmp_gt_u32 s67, 16000000
    s_cbranch_scc1 L_end
    s_sleep 1
    s_branch LW_3
L_chain:
    s_cmp_eq_u32 s3, 3
    s_cbranch_scc1 L_xwave
    s_setprio 2
    s_mul_i32 s8, s4, 768
    s_lshl_b32 s9, s3, 8
    s_add_u32 s8, s8, s9
    s_add_u32 s8, s8, 196608
    s_add_u32 s60, s40, s8
    s_addc_u32 s61, s41, 0
    v_lshlrev_b32 v5, 2, v0
    v_lshl_add_u32 v5, s3, 7, v5
    v_mov_b32 v6, 0
    v_mov_b32 v7, 1
    s_waitcnt lgkmcnt(0)
    s_add_u32 s88, s6, 0x9e3779b9
L_qpoll:
    s_load_dwordx16 s[44:59], s[60:61], 0 glc
    s_load_dwordx16 s[68:83], s[60:61], 64 glc
    s_load_dwordx8 s[8:15], s[60:61], 128 glc
    s_load_dwordx4 s[84:87], s[60:61], 160 glc
    s_waitcnt lgkmcnt(0)
    s_xor_b32 s89, s47, s88
    s_xor_b32 s90, s51, s88
    s_or_b32 s89, s89, s90
    s_xor_b32 s90, s55, s88
    s_or_b32 s89, s89, s90
    s_xor_b32 s90, s59, s88
    s_or_b32 s89, s89, s90
    s_xor_b32 s90, s71, s88
    s_or_b32 s89, s89, s90
    s_xor_b32 s90, s75, s88
    s_or_b32 s89, s89, s90
    s_xor_b32 s90, s79, s88
    s_or_b32 s89, s89, s90
    s_xor_b32 s90, s83, s88
    s_or_b32 s89, s89, s90
    s_xor_b32 s90, s11, s88
    s_or_b32 s89, s89, s90
    s_xor_b32 s90, s15, s88
    s_or_b32 s89, s89, s90
    s_xor_b32 s90, s87, s88
    s_or_b32 s89, s89, s90
    s_cbranch_scc0 L_qgot
    s_add_u32 s67, s67, 1
    s_cmp_gt_u32 s67, 2000000
    s_cbranch_scc1 L_end
    s_sleep 2
    s_branch L_qpoll
L_qgot:
    v_writelane_b32 v4, s44, 0
    v_writelane_b32 v4, s45, 1
    v_writelane_b32 v4, s46, 2
    v_writelane_b32 v4, s48, 3
    v_writelane_b32 v4, s49, 4
    v_writelane_b32 v4, s50, 5
    v_writelane_b32 v4, s52, 6
    v_writelane_b32 v4, s53, 7
    v_writelane_b32 v4, s54, 8
    v_writelane_b32 v4, s56, 9
    v_writelane_b32 v4, s57, 10
    v_writelane_b32 v4, s58, 11
    v_writelane_b32 v4, s68, 12
    v_writelane_b32 v4, s69, 13
    v_writelane_b32 v4, s70, 14
    v_writelane_b32 v4, s72, 15
    v_writelane_b32 v4, s73, 16
    v_writelane_b32 v4, s74, 17
    v_writelane_b32 v4, s76, 18
    v_writelane_b32 v4, s77, 19
    v_writelane_b32 v4, s78, 20
    v_writelane_b32 v4, s80, 21
    v_writelane_b32 v4, s81, 22
    v_writelane_b32 v4, s82, 23
    v_writelane_b32 v4, s8, 24
    v_writelane_b32 v4, s9, 25
    v_writelane_b32 v4, s10, 26
    v_writelane_b32 v4, s12, 27
    v_writelane_b32 v4, s13, 28
    v_writelane_b32 v4, s14, 29
    v_writelane_b32 v4, s84, 30
    v_writelane_b32 v4, s85, 31
    s_mov_b32 exec_hi, 0
    ds_write_b32 v5, v4 offset:0
    s_mov_b64 exec, 1
    ds_add_u32 v6, v7 offset:512
    s_mov_b64 exec, -1
    s_branch L_tail
L_xwave:
    s_cmp_lt_u32 s2, 216
    s_cbranch_scc1 L_tail
    s_sub_u32 s9, s2, 196
L_xrest:
    v_mul_u32_u24 v4, 7680, v2
    v_lshl_add_u32 v4, v3, 4, v4
    s_lshl_b32 s14, s9, 7
    s_add_u32 s52, s34, s14
    s_addc_u32 s53, s35, 0
    s_sub_u32 s54, 4915200, s14
    s_mov_b32 s10, 0
    s_mov_b32 s11, 0
    v_lshlrev_b32 v7, 1, v2
    v_mov_b32 v6, 0
    v_mov_b32 v88, 0
    v_mov_b32 v89, 0
    v_mov_b32 v90, 0
    v_mov_b32 v91, 0
    v_mov_b32 v92, 0
    v_mov_b32 v93, 0
    v_mov_b32 v94, 0
    v_mov_b32 v95, 0
LW_4:
    ds_read_b32 v5, v6 offset:512
    s_waitcnt lgkmcnt(0)
    v_readfirstlane_b32 s8, v5
    s_nop 0
    s_cmp_ge_u32 s8, 3
    s_cbranch_scc1 L_xrloop
    s_add_u32 s67, s67, 1
    s_cmp_gt_u32 s67, 16000000
    s_cbranch_scc1 L_end
    s_sleep 4
    s_branch LW_4
L_xrloop:
    global_load_ushort v24, v7, s[32:33] offset:0
    global_load_ushort v25, v7, s[32:33] offset:16
    global_load_ushort v26, v7, s[32:33] offset:32
    global_load_ushort v27, v7, s[32:33] offset:48
    global_load_ushort v28, v7, s[32:33] offset:64
    global_load_ushort v29, v7, s[32:33] offset:80
    global_load_ushort v30, v7, s[32:33] offset:96
    global_load_ushort v31, v7, s[32:33] offset:112
    global_load_ushort v32, v7, s[32:33] offset:128
    global_load_ushort v33, v7, s[32:33] offset:144
    buffer_load_dwordx4 v[48:51], v4, s[52:55], s10 offen nt
    s_add_u32 s10, s10, 61440
    buffer_load_dwordx4 v[52:55], v4, s[52:55], s10 offen nt
    s_add_u32 s10, s10, 61440
    buffer_load_dwordx4 v[56:59], v4, s[52:55], s10 offen nt
    s_add_u32 s10, s10, 61440
    buffer_load_dwordx4 v[60:63], v4, s[52:55], s10 offen nt
    s_add_u32 s10, s10, 61440
    buffer_load_dwordx4 v[64:67], v4, s[52:55], s10 offen nt
    s_add_u32 s10, s10, 61440
    buffer_load_dwordx4 v[68:71], v4, s[52:55], s10 offen nt
    s_add_u32 s10, s10, 61440
    buffer_load_dwordx4 v[72:75], v4, s[52:55], s10 offen nt
    s_add_u32 s10, s10, 61440
    buffer_load_dwordx4 v[76:79], v4, s[52:55], s10 offen nt
    s_add_u32 s10, s10, 61440
    buffer_load_dwordx4 v[80:83], v4, s[52:55], s10 offen nt
    s_add_u32 s10, s10, 61440
    buffer_load_dwordx4 v[84:87], v4, s[52:55], s10 offen nt
    s_add_u32 s10, s10, 61440
    s_waitcnt vmcnt(10)
    v_lshlrev_b32 v24, 16, v24
    v_mul_f32 v34, s42, v24
    v_exp_f32 v34, -v34
    s_nop 0
    v_add_f32 v34, 1.0, v34
    v_rcp_f32 v34, v34
    s_nop 0
    v_mul_f32 v24, v24, v34
    v_cvt_pk_bf16_f32 v24, v24, v24
    v_and_b32 v24, s7, v24
    v_lshrrev_b32 v34, 16, v24
    v_lshlrev_b32 v25, 16, v25
    v_mul_f32 v35, s42, v25
    v_exp_f32 v35, -v35
    s_nop 0
    v_add_f32 v35, 1.0, v35
    v_rcp_f32 v35, v35
    s_nop 0
    v_mul_f32 v25, v25, v35
    v_cvt_pk_bf16_f32 v25, v25, v25
    v_and_b32 v25, s7, v25
    v_lshrrev_b32 v35, 16, v25
    v_lshlrev_b32 v26, 16, v26
    v_mul_f32 v36, s42, v26
    v_exp_f32 v36, -v36
    s_nop 0
    v_add_f32 v36, 1.0, v36
    v_rcp_f32 v36, v36
    s_nop 0
    v_mul_f32 v26, v26, v36
    v_cvt_pk_bf16_f32 v26, v26, v26
    v_and_b32 v26, s7, v26
    v_lshrrev_b32 v36, 16, v26
    v_lshlrev_b32 v27, 16, v27
    v_mul_f32 v37, s42, v27
    v_exp_f32 v37, -v37
    s_nop 0
    v_add_f32 v37, 1.0, v37
    v_rcp_f32 v37, v37
    s_nop 0
    v_mul_f32 v27, v27, v37
    v_cvt_pk_bf16_f32 v27, v27, v27
    v_and_b32 v27, s7, v27
    v_lshrrev_b32 v37, 16, v27
    v_lshlrev_b32 v28, 16, v28
    v_mul_f32 v38, s42, v28
    v_exp_f32 v38, -v38
    s_nop 0
    v_add_f32 v38, 1.0, v38
    v_rcp_f32 v38, v38
    s_nop 0
    v_mul_f32 v28, v28, v38
    v_cvt_pk_bf16_f32 v28, v28, v28
    v_and_b32 v28, s7, v28
    v_lshrrev_b32 v38, 16, v28
    v_lshlrev_b32 v29, 16, v29
    v_mul_f32 v39, s42, v29
    v_exp_f32 v39, -v39
    s_nop 0
    v_add_f32 v39, 1.0, v39
    v_rcp_f32 v39, v39
    s_nop 0
    v_mul_f32 v29, v29, v39
    v_cvt_pk_bf16_f32 v29, v29, v29
    v_and_b32 v29, s7, v29
    v_lshrrev_b32 v39, 16, v29
    v_lshlrev_b32 v30, 16, v30
    v_mul_f32 v40, s42, v30
    v_exp_f32 v40, -v40
    s_nop 0
    v_add_f32 v40, 1.0, v40
    v_rcp_f32 v40, v40
    s_nop 0
    v_mul_f32 v30, v30, v40
    v_cvt_pk_bf16_f32 v30, v30, v30
    v_and_b32 v30, s7, v30
    v_lshrrev_b32 v40, 16, v30
    v_lshlrev_b32 v31, 16, v31
    v_mul_f32 v41, s42, v31
    v_exp_f32 v41, -v41
    s_nop 0
    v_add_f32 v41, 1.0, v41
    v_rcp_f32 v41, v41
    s_nop 0
    v_mul_f32 v31, v31, v41
    v_cvt_pk_bf16_f32 v31, v31, v31
    v_and_b32 v31, s7, v31
    v_lshrrev_b32 v41, 16, v31
    v_lshlrev_b32 v32, 16, v32
    v_mul_f32 v42, s42, v32
    v_exp_f32 v42, -v42
    s_nop 0
    v_add_f32 v42, 1.0, v42
    v_rcp_f32 v42, v42
    s_nop 0
    v_mul_f32 v32, v32, v42
    v_cvt_pk_bf16_f32 v32, v32, v32
    v_and_b32 v32, s7, v32
    v_lshrrev_b32 v42, 16, v32
    v_lshlrev_b32 v33, 16, v33
    v_mul_f32 v43, s42, v33
    v_exp_f32 v43, -v43
    s_nop 0
    v_add_f32 v43, 1.0, v43
    v_rcp_f32 v43, v43
    s_nop 0
    v_mul_f32 v33, v33, v43
    v_cvt_pk_bf16_f32 v33, v33, v33
    v_and_b32 v33, s7, v33
    v_lshrrev_b32 v43, 16, v33
    s_waitcnt vmcnt(0)
    v_dot2c_f32_bf16 v88, v48, v34
    v_dot2c_f32_bf16 v89, v48, v24
    v_dot2c_f32_bf16 v90, v49, v34
    v_dot2c_f32_bf16 v91, v49, v24
    v_dot2c_f32_bf16 v92, v50, v34
    v_dot2c_f32_bf16 v93, v50, v24
    v_dot2c_f32_bf16 v94, v51, v34
    v_dot2c_f32_bf16 v95, v51, v24
    v_dot2c_f32_bf16 v88, v52, v35
    v_dot2c_f32_bf16 v89, v52, v25
    v_dot2c_f32_bf16 v90, v53, v35
    v_dot2c_f32_bf16 v91, v53, v25
    v_dot2c_f32_bf16 v92, v54, v35
    v_dot2c_f32_bf16 v93, v54, v25
    v_dot2c_f32_bf16 v94, v55, v35
    v_dot2c_f32_bf16 v95, v55, v25
    v_dot2c_f32_bf16 v88, v56, v36
    v_dot2c_f32_bf16 v89, v56, v26
    v_dot2c_f32_bf16 v90, v57, v36
    v_dot2c_f32_bf16 v91, v57, v26
    v_dot2c_f32_bf16 v92, v58, v36
    v_dot2c_f32_bf16 v93, v58, v26
    v_dot2c_f32_bf16 v94, v59, v36
    v_dot2c_f32_bf16 v95, v59, v26
    v_dot2c_f32_bf16 v88, v60, v37
    v_dot2c_f32_bf16 v89, v60, v27
    v_dot2c_f32_bf16 v90, v61, v37
    v_dot2c_f32_bf16 v91, v61, v27
    v_dot2c_f32_bf16 v92, v62, v37
    v_dot2c_f32_bf16 v93, v62, v27
    v_dot2c_f32_bf16 v94, v63, v37
    v_dot2c_f32_bf16 v95, v63, v27
    v_dot2c_f32_bf16 v88, v64, v38
    v_dot2c_f32_bf16 v89, v64, v28
    v_dot2c_f32_bf16 v90, v65, v38
    v_dot2c_f32_bf16 v91, v65, v28
    v_dot2c_f32_bf16 v92, v66, v38
    v_dot2c_f32_bf16 v93, v66, v28
    v_dot2c_f32_bf16 v94, v67, v38
    v_dot2c_f32_bf16 v95, v67, v28
    v_dot2c_f32_bf16 v88, v68, v39
    v_dot2c_f32_bf16 v89, v68, v29
    v_dot2c_f32_bf16 v90, v69, v39
    v_dot2c_f32_bf16 v91, v69, v29
    v_dot2c_f32_bf16 v92, v70, v39
    v_dot2c_f32_bf16 v93, v70, v29
    v_dot2c_f32_bf16 v94, v71, v39
    v_dot2c_f32_bf16 v95, v71, v29
    v_dot2c_f32_bf16 v88, v72, v40
    v_dot2c_f32_bf16 v89, v72, v30
    v_dot2c_f32_bf16 v90, v73, v40
    v_dot2c_f32_bf16 v91, v73, v30
    v_dot2c_f32_bf16 v92, v74, v40
    v_dot2c_f32_bf16 v93, v74, v30
    v_dot2c_f32_bf16 v94, v75, v40
    v_dot2c_f32_bf16 v95, v75, v30
    v_dot2c_f32_bf16 v88, v76, v41
    v_dot2c_f32_bf16 v89, v76, v31
    v_dot2c_f32_bf16 v90, v77, v41
    v_dot2c_f32_bf16 v91, v77, v31
    v_dot2c_f32_bf16 v92, v78, v41
    v_dot2c_f32_bf16 v93, v78, v31
    v_dot2c_f32_bf16 v94, v79, v41
    v_dot2c_f32_bf16 v95, v79, v31
    v_dot2c_f32_bf16 v88, v80, v42
    v_dot2c_f32_bf16 v89, v80, v32
    v_dot2c_f32_bf16 v90, v81, v42
    v_dot2c_f32_bf16 v91, v81, v32
    v_dot2c_f32_bf16 v92, v82, v42
    v_dot2c_f32_bf16 v93, v82, v32
    v_dot2c_f32_bf16 v94, v83, v42
    v_dot2c_f32_bf16 v95, v83, v32
    v_dot2c_f32_bf16 v88, v84, v43
    v_dot2c_f32_bf16 v89, v84, v33
    v_dot2c_f32_bf16 v90, v85, v43
    v_dot2c_f32_bf16 v91, v85, v33
    v_dot2c_f32_bf16 v92, v86, v43
    v_dot2c_f32_bf16 v93, v86, v33
    v_dot2c_f32_bf16 v94, v87, v43
    v_dot2c_f32_bf16 v95, v87, v33
    v_add_u32 v7, 160, v7
    s_add_u32 s11, s11, 1
    s_cmp_lt_u32 s11, 8
    s_cbranch_scc1 L_xrloop
    v_permlane32_swap_b32 v88, v92
    v_permlane32_swap_b32 v89, v93
    v_permlane32_swap_b32 v90, v94
    v_permlane32_swap_b32 v91, v95
    v_add_f32 v88, v88, v92
    v_add_f32 v89, v89, v93
    v_add_f32 v90, v90, v94
    v_add_f32 v91, v91, v95
    s_nop 0
    v_permlane16_swap_b32 v88, v90
    v_permlane16_swap_b32 v89, v91
    v_add_f32 v88, v88, v90
    v_add_f32 v89, v89, v91
    s_nop 0
    v_add_f32_dpp v88, v88, v88 row_ror:8 row_mask:0xf bank_mask:0xf
    v_add_f32_dpp v89, v89, v89 row_ror:8 row_mask:0xf bank_mask:0xf
    v_cndmask_b32 v88, v88, v89, s[12:13]
    v_cvt_pk_bf16_f32 v88, v88, v88
    v_and_b32 v88, s7, v88
    s_lshl_b32 s9, s9, 9
    s_add_u32 s9, s9, 65536
    s_add_u32 s8, s6, 0x9e3779b9
    v_lshl_add_u32 v5, v3, 3, v2
    v_lshl_add_u32 v5, v5, 3, s9
    v_mov_b32 v89, s8
    global_store_dwordx2 v5, v[88:89], s[40:41] sc1
    s_branch L_tail
L_qready:
    v_lshlrev_b32 v4, 4, v3
    ds_read_b128 v[10:13], v4 offset:0
    ds_read_b128 v[14:17], v4 offset:128
    ds_read_b128 v[18:21], v4 offset:256
    v_mov_b32 v22, 0xff7fffff
    v_mov_b32 v23, 0
    v_mov_b32 v124, 0
    v_mov_b32 v125, 1
    v_mov_b32 v24, 0
    v_mov_b32 v25, 0
    v_mov_b32 v26, 0
    v_mov_b32 v27, 0
    v_mov_b32 v28, 0
    v_mov_b32 v29, 0
    v_mov_b32 v30, 0
    v_mov_b32 v31, 0
    v_mov_b32 v32, 0
    v_mov_b32 v33, 0
    v_mov_b32 v34, 0
    v_mov_b32 v35, 0
    v_mov_b32 v36, 0
    v_mov_b32 v37, 0
    v_mov_b32 v38, 0
    v_mov_b32 v39, 0
    v_mov_b32 v40, 0
    v_mov_b32 v41, 0
    v_mov_b32 v42, 0
    v_mov_b32 v43, 0
    v_mov_b32 v44, 0
    v_mov_b32 v45, 0
    v_mov_b32 v46, 0
    v_mov_b32 v47, 0
    s_waitcnt lgkmcnt(0)
    s_cmp_ge_u32 s3, 12
    s_cbranch_scc1 L_catch2
    s_cmp_lt_u32 s5, 3
    s_cbranch_scc1 L_kgo
    s_waitcnt vmcnt(21)
    v_mov_b32 v2, 0
    v_mov_b32 v3, 0
    v_mov_b32 v4, 0
    v_dot2c_f32_bf16 v2, v48, v10
    v_dot2c_f32_bf16 v3, v52, v14
    v_dot2c_f32_bf16 v4, v56, v18
    v_dot2c_f32_bf16 v2, v49, v11
    v_dot2c_f32_bf16 v3, v53, v15
    v_dot2c_f32_bf16 v4, v57, v19
    v_dot2c_f32_bf16 v2, v50, v12
    v_dot2c_f32_bf16 v3, v54, v16
    v_dot2c_f32_bf16 v4, v58, v20
    v_dot2c_f32_bf16 v2, v51, v13
    v_dot2c_f32_bf16 v3, v55, v17
    v_dot2c_f32_bf16 v4, v59, v21
    buffer_load_dwordx4 v[48:51], v1, s[44:47], s62 offen offset:0 nt
    buffer_load_dwordx4 v[52:55], v1, s[44:47], s62 offen offset:128 nt
    buffer_load_dwordx4 v[56:59], v1, s[44:47], s62 offen offset:256 nt
    s_add_u32 s62, s62, 24576
    v_add_f32 v2, v2, v3
    v_add_f32 v2, v2, v4
    s_nop 1
    v_add_f32_dpp v2, v2, v2 quad_perm:[1,0,3,2] row_mask:0xf bank_mask:0xf
    s_nop 1
    v_add_f32_dpp v2, v2, v2 quad_perm:[2,3,0,1] row_mask:0xf bank_mask:0xf
    s_nop 1
    v_add_f32_dpp v2, v2, v2 row_half_mirror row_mask:0xf bank_mask:0xf
    v_cvt_pk_bf16_f32 v2, v2, v2
    v_and_b32 v2, s7, v2
    v_mul_f32 v2, s43, v2
    v_cvt_pk_bf16_f32 v2, v2, v2
    v_and_b32 v2, s7, v2
    v_min_u32 v2, -2, v2
    ds_write_b32 v9, v2 offset:0
    s_waitcnt vmcnt(21)
    v_mov_b32 v2, 0
    v_mov_b32 v3, 0
    v_mov_b32 v4, 0
    v_dot2c_f32_bf16 v2, v60, v10
    v_dot2c_f32_bf16 v3, v64, v14
    v_dot2c_f32_bf16 v4, v68, v18
    v_dot2c_f32_bf16 v2, v61, v11
    v_dot2c_f32_bf16 v3, v65, v15
    v_dot2c_f32_bf16 v4, v69, v19
    v_dot2c_f32_bf16 v2, v62, v12
    v_dot2c_f32_bf16 v3, v66, v16
    v_dot2c_f32_bf16 v4, v70, v20
    v_dot2c_f32_bf16 v2, v63, v13
    v_dot2c_f32_bf16 v3, v67, v17
    v_dot2c_f32_bf16 v4, v71, v21
    buffer_load_dwordx4 v[60:63], v1, s[44:47], s62 offen offset:0 nt
    buffer_load_dwordx4 v[64:67], v1, s[44:47], s62 offen offset:128 nt
    buffer_load_dwordx4 v[68:71], v1, s[44:47], s62 offen offset:256 nt
    v_add_f32 v2, v2, v3
    v_add_f32 v2, v2, v4
    s_nop 1
    v_add_f32_dpp v2, v2, v2 quad_perm:[1,0,3,2] row_mask:0xf bank_mask:0xf
    s_nop 1
    v_add_f32_dpp v2, v2, v2 quad_perm:[2,3,0,1] row_mask:0xf bank_mask:0xf
    s_nop 1
    v_add_f32_dpp v2, v2, v2 row_half_mirror row_mask:0xf bank_mask:0xf
    v_cvt_pk_bf16_f32 v2, v2, v2
    v_and_b32 v2, s7, v2
    v_mul_f32 v2, s43, v2
    v_cvt_pk_bf16_f32 v2, v2, v2
    v_and_b32 v2, s7, v2
    v_min_u32 v2, -2, v2
    ds_write_b32 v9, v2 offset:384
    s_waitcnt vmcnt(21)
    v_mov_b32 v2, 0
    v_mov_b32 v3, 0
    v_mov_b32 v4, 0
    v_dot2c_f32_bf16 v2, v72, v10
    v_dot2c_f32_bf16 v3, v76, v14
    v_dot2c_f32_bf16 v4, v80, v18
    v_dot2c_f32_bf16 v2, v73, v11
    v_dot2c_f32_bf16 v3, v77, v15
    v_dot2c_f32_bf16 v4, v81, v19
    v_dot2c_f32_bf16 v2, v74, v12
    v_dot2c_f32_bf16 v3, v78, v16
    v_dot2c_f32_bf16 v4, v82, v20
    v_dot2c_f32_bf16 v2, v75, v13
    v_dot2c_f32_bf16 v3, v79, v17
    v_dot2c_f32_bf16 v4, v83, v21
    s_nop 1
    v_add_f32 v2, v2, v3
    v_add_f32 v2, v2, v4
    s_nop 1
    v_add_f32_dpp v2, v2, v2 quad_perm:[1,0,3,2] row_mask:0xf bank_mask:0xf
    s_nop 1
    v_add_f32_dpp v2, v2, v2 quad_perm:[2,3,0,1] row_mask:0xf bank_mask:0xf
    s_nop 1
    v_add_f32_dpp v2, v2, v2 row_half_mirror row_mask:0xf bank_mask:0xf
    v_cvt_pk_bf16_f32 v2, v2, v2
    v_and_b32 v2, s7, v2
    v_mul_f32 v2, s43, v2
    v_cvt_pk_bf16_f32 v2, v2, v2
    v_and_b32 v2, s7, v2
    v_min_u32 v2, -2, v2
    ds_write_b32 v9, v2 offset:768
    s_waitcnt vmcnt(18)
    v_mov_b32 v2, 0
    v_mov_b32 v3, 0
    v_mov_b32 v4, 0
    v_dot2c_f32_bf16 v2, v84, v10
    v_dot2c_f32_bf16 v3, v88, v14
    v_dot2c_f32_bf16 v4, v92, v18
    v_dot2c_f32_bf16 v2, v85, v11
    v_dot2c_f32_bf16 v3, v89, v15
    v_dot2c_f32_bf16 v4, v93, v19
    v_dot2c_f32_bf16 v2, v86, v12
    v_dot2c_f32_bf16 v3, v90, v16
    v_dot2c_f32_bf16 v4, v94, v20
    v_dot2c_f32_bf16 v2, v87, v13
    v_dot2c_f32_bf16 v3, v91, v17
    v_dot2c_f32_bf16 v4, v95, v21
    s_nop 1
    v_add_f32 v2, v2, v3
    v_add_f32 v2, v2, v4
    s_nop 1
    v_add_f32_dpp v2, v2, v2 quad_perm:[1,0,3,2] row_mask:0xf bank_mask:0xf
    s_nop 1
    v_add_f32_dpp v2, v2, v2 quad_perm:[2,3,0,1] row_mask:0xf bank_mask:0xf
    s_nop 1
    v_add_f32_dpp v2, v2, v2 row_half_mirror row_mask:0xf bank_mask:0xf
    v_cvt_pk_bf16_f32 v2, v2, v2
    v_and_b32 v2, s7, v2
    v_mul_f32 v2, s43, v2
    v_cvt_pk_bf16_f32 v2, v2, v2
    v_and_b32 v2, s7, v2
    v_min_u32 v2, -2, v2
    ds_write_b32 v9, v2 offset:1152
    s_waitcnt vmcnt(15)
    v_mov_b32 v2, 0
    v_mov_b32 v3, 0
    v_mov_b32 v4, 0
    v_dot2c_f32_bf16 v2, v96, v10
    v_dot2c_f32_bf16 v3, v100, v14
    v_dot2c_f32_bf16 v4, v104, v18
    v_dot2c_f32_bf16 v2, v97, v11
    v_dot2c_f32_bf16 v3, v101, v15
    v_dot2c_f32_bf16 v4, v105, v19
    v_dot2c_f32_bf16 v2, v98, v12
    v_dot2c_f32_bf16 v3, v102, v16
    v_dot2c_f32_bf16 v4, v106, v20
    v_dot2c_f32_bf16 v2, v99, v13
    v_dot2c_f32_bf16 v3, v103, v17
    v_dot2c_f32_bf16 v4, v107, v21
    s_nop 1
    v_add_f32 v2, v2, v3
    v_add_f32 v2, v2, v4
    s_nop 1
    v_add_f32_dpp v2, v2, v2 quad_perm:[1,0,3,2] row_mask:0xf bank_mask:0xf
    s_nop 1
    v_add_f32_dpp v2, v2, v2 quad_perm:[2,3,0,1] row_mask:0xf bank_mask:0xf
    s_nop 1
    v_add_f32_dpp v2, v2, v2 row_half_mirror row_mask:0xf bank_mask:0xf
    v_cvt_pk_bf16_f32 v2, v2, v2
    v_and_b32 v2, s7, v2
    v_mul_f32 v2, s43, v2
    v_cvt_pk_bf16_f32 v2, v2, v2
    v_and_b32 v2, s7, v2
    v_min_u32 v2, -2, v2
    ds_write_b32 v9, v2 offset:1536
    s_waitcnt vmcnt(12)
    v_mov_b32 v2, 0
    v_mov_b32 v3, 0
    v_mov_b32 v4, 0
    v_dot2c_f32_bf16 v2, v108, v10
    v_dot2c_f32_bf16 v3, v112, v14
    v_dot2c_f32_bf16 v4, v116, v18
    v_dot2c_f32_bf16 v2, v109, v11
    v_dot2c_f32_bf16 v3, v113, v15
    v_dot2c_f32_bf16 v4, v117, v19
    v_dot2c_f32_bf16 v2, v110, v12
    v_dot2c_f32_bf16 v3, v114, v16
    v_dot2c_f32_bf16 v4, v118, v20
    v_dot2c_f32_bf16 v2, v111, v13
    v_dot2c_f32_bf16 v3, v115, v17
    v_dot2c_f32_bf16 v4, v119, v21
    s_nop 1
    v_add_f32 v2, v2, v3
    v_add_f32 v2, v2, v4
    s_nop 1
    v_add_f32_dpp v2, v2, v2 quad_perm:[1,0,3,2] row_mask:0xf bank_mask:0xf
    s_nop 1
    v_add_f32_dpp v2, v2, v2 quad_perm:[2,3,0,1] row_mask:0xf bank_mask:0xf
    s_nop 1
    v_add_f32_dpp v2, v2, v2 row_half_mirror row_mask:0xf bank_mask:0xf
    v_cvt_pk_bf16_f32 v2, v2, v2
    v_and_b32 v2, s7, v2
    v_mul_f32 v2, s43, v2
    v_cvt_pk_bf16_f32 v2, v2, v2
    v_and_b32 v2, s7, v2
    v_min_u32 v2, -2, v2
    ds_write_b32 v9, v2 offset:1920
    s_waitcnt vmcnt(6)
    v_lshl_add_u32 v120, v0, 4, s11
    ds_read_b128 v[72:75], v120 offset:16384
    ds_read_b128 v[76:79], v120 offset:17408
    ds_read_b128 v[80:83], v120 offset:18432
    ds_read_b128 v[84:87], v120 offset:19456
    ds_read_b128 v[88:91], v120 offset:20480
    ds_read_b128 v[92:95], v120 offset:21504
    s_waitcnt lgkmcnt(3)
    v_mov_b32 v2, 0
    v_mov_b32 v3, 0
    v_mov_b32 v4, 0
    v_dot2c_f32_bf16 v2, v72, v10
    v_dot2c_f32_bf16 v3, v76, v14
    v_dot2c_f32_bf16 v4, v80, v18
    v_dot2c_f32_bf16 v2, v73, v11
    v_dot2c_f32_bf16 v3, v77, v15
    v_dot2c_f32_bf16 v4, v81, v19
    v_dot2c_f32_bf16 v2, v74, v12
    v_dot2c_f32_bf16 v3, v78, v16
    v_dot2c_f32_bf16 v4, v82, v20
    v_dot2c_f32_bf16 v2, v75, v13
    v_dot2c_f32_bf16 v3, v79, v17
    v_dot2c_f32_bf16 v4, v83, v21
    s_nop 1
    v_add_f32 v2, v2, v3
    v_add_f32 v2, v2, v4
    s_nop 1
    v_add_f32_dpp v2, v2, v2 quad_perm:[1,0,3,2] row_mask:0xf bank_mask:0xf
    s_nop 1
    v_add_f32_dpp v2, v2, v2 quad_perm:[2,3,0,1] row_mask:0xf bank_mask:0xf
    s_nop 1
    v_add_f32_dpp v2, v2, v2 row_half_mirror row_mask:0xf bank_mask:0xf
    v_cvt_pk_bf16_f32 v2, v2, v2
    v_and_b32 v2, s7, v2
    v_mul_f32 v2, s43, v2
    v_cvt_pk_bf16_f32 v2, v2, v2
    v_and_b32 v2, s7, v2
    v_min_u32 v2, -2, v2
    ds_write_b32 v9, v2 offset:2304
    s_waitcnt lgkmcnt(0)
    v_mov_b32 v2, 0
    v_mov_b32 v3, 0
    v_mov_b32 v4, 0
    v_dot2c_f32_bf16 v2, v84, v10
    v_dot2c_f32_bf16 v3, v88, v14
    v_dot2c_f32_bf16 v4, v92, v18
    v_dot2c_f32_bf16 v2, v85, v11
    v_dot2c_f32_bf16 v3, v89, v15
    v_dot2c_f32_bf16 v4, v93, v19
    v_dot2c_f32_bf16 v2, v86, v12
    v_dot2c_f32_bf16 v3, v90, v16
    v_dot2c_f32_bf16 v4, v94, v20
    v_dot2c_f32_bf16 v2, v87, v13
    v_dot2c_f32_bf16 v3, v91, v17
    v_dot2c_f32_bf16 v4, v95, v21
    s_nop 1
    v_add_f32 v2, v2, v3
    v_add_f32 v2, v2, v4
    s_nop 1
    v_add_f32_dpp v2, v2, v2 quad_perm:[1,0,3,2] row_mask:0xf bank_mask:0xf
    s_nop 1
    v_add_f32_dpp v2, v2, v2 quad_perm:[2,3,0,1] row_mask:0xf bank_mask:0xf
    s_nop 1
    v_add_f32_dpp v2, v2, v2 row_half_mirror row_mask:0xf bank_mask:0xf
    v_cvt_pk_bf16_f32 v2, v2, v2
    v_and_b32 v2, s7, v2
    v_mul_f32 v2, s43, v2
    v_cvt_pk_bf16_f32 v2, v2, v2
    v_and_b32 v2, s7, v2
    v_min_u32 v2, -2, v2
    ds_write_b32 v9, v2 offset:2688
L_kgo:
    s_mov_b64 exec, 1
    ds_add_rtn_u32 v126, v124, v125 offset:544
    s_mov_b64 exec, -1
L_kloop:
    s_waitcnt vmcnt(3)
    v_add_u32 v9, s74, v8
    v_mov_b32 v2, 0
    v_mov_b32 v3, 0
    v_mov_b32 v4, 0
    v_dot2c_f32_bf16 v2, v48, v10
    v_dot2c_f32_bf16 v3, v52, v14
    v_dot2c_f32_bf16 v4, v56, v18
    v_dot2c_f32_bf16 v2, v49, v11
    v_dot2c_f32_bf16 v3, v53, v15
    v_dot2c_f32_bf16 v4, v57, v19
    v_dot2c_f32_bf16 v2, v50, v12
    v_dot2c_f32_bf16 v3, v54, v16
    v_dot2c_f32_bf16 v4, v58, v20
    v_dot2c_f32_bf16 v2, v51, v13
    v_dot2c_f32_bf16 v3, v55, v17
    v_dot2c_f32_bf16 v4, v59, v21
    s_waitcnt lgkmcnt(0)
    v_readfirstlane_b32 s8, v126
    s_nop 0
    s_cmp_ge_u32 s8, s65
    s_cbranch_scc1 L_kend0
    s_mul_i32 s62, s8, 3072
    s_add_u32 s62, s62, s64
    s_lshl_b32 s74, s8, 5
    buffer_load_dwordx4 v[48:51], v1, s[44:47], s62 offen offset:0 nt
    buffer_load_dwordx4 v[52:55], v1, s[44:47], s62 offen offset:128 nt
    buffer_load_dwordx4 v[56:59], v1, s[44:47], s62 offen offset:256 nt
    s_mov_b64 exec, 1
    ds_add_rtn_u32 v126, v124, v125 offset:544
    s_mov_b64 exec, -1
    v_add_f32 v2, v2, v3
    v_add_f32 v2, v2, v4
    s_nop 1
    v_add_f32_dpp v2, v2, v2 quad_perm:[1,0,3,2] row_mask:0xf bank_mask:0xf
    s_nop 1
    v_add_f32_dpp v2, v2, v2 quad_perm:[2,3,0,1] row_mask:0xf bank_mask:0xf
    s_nop 1
    v_add_f32_dpp v2, v2, v2 row_half_mirror row_mask:0xf bank_mask:0xf
    v_cvt_pk_bf16_f32 v2, v2, v2
    v_and_b32 v2, s7, v2
    v_mul_f32 v2, s43, v2
    v_cvt_pk_bf16_f32 v2, v2, v2
    v_and_b32 v2, s7, v2
    v_min_u32 v2, -2, v2
    ds_write_b32 v9, v2 offset:0
    s_waitcnt vmcnt(3)
    v_add_u32 v9, s75, v8
    v_mov_b32 v2, 0
    v_mov_b32 v3, 0
    v_mov_b32 v4, 0
    v_dot2c_f32_bf16 v2, v60, v10
    v_dot2c_f32_bf16 v3, v64, v14
    v_dot2c_f32_bf16 v4, v68, v18
    v_dot2c_f32_bf16 v2, v61, v11
    v_dot2c_f32_bf16 v3, v65, v15
    v_dot2c_f32_bf16 v4, v69, v19
    v_dot2c_f32_bf16 v2, v62, v12
    v_dot2c_f32_bf16 v3, v66, v16
    v_dot2c_f32_bf16 v4, v70, v20
    v_dot2c_f32_bf16 v2, v63, v13
    v_dot2c_f32_bf16 v3, v67, v17
    v_dot2c_f32_bf16 v4, v71, v21
    s_waitcnt lgkmcnt(0)
    v_readfirstlane_b32 s8, v126
    s_nop 0
    s_cmp_ge_u32 s8, s65
    s_cbranch_scc1 L_kend1
    s_mul_i32 s62, s8, 3072
    s_add_u32 s62, s62, s64
    s_lshl_b32 s75, s8, 5
    buffer_load_dwordx4 v[60:63], v1, s[44:47], s62 offen offset:0 nt
    buffer_load_dwordx4 v[64:67], v1, s[44:47], s62 offen offset:128 nt
    buffer_load_dwordx4 v[68:71], v1, s[44:47], s62 offen offset:256 nt
    s_mov_b64 exec, 1
    ds_add_rtn_u32 v126, v124, v125 offset:544
    s_mov_b64 exec, -1
    v_add_f32 v2, v2, v3
    v_add_f32 v2, v2, v4
    s_nop 1
    v_add_f32_dpp v2, v2, v2 quad_perm:[1,0,3,2] row_mask:0xf bank_mask:0xf
    s_nop 1
    v_add_f32_dpp v2, v2, v2 quad_perm:[2,3,0,1] row_mask:0xf bank_mask:0xf
    s_nop 1
    v_add_f32_dpp v2, v2, v2 row_half_mirror row_mask:0xf bank_mask:0xf
    v_cvt_pk_bf16_f32 v2, v2, v2
    v_and_b32 v2, s7, v2
    v_mul_f32 v2, s43, v2
    v_cvt_pk_bf16_f32 v2, v2, v2
    v_and_b32 v2, s7, v2
    v_min_u32 v2, -2, v2
    ds_write_b32 v9, v2 offset:0
    s_branch L_kloop
L_kend0:
    s_add_u32 s8, s3, -4
    s_mul_i32 s62, s8, 3072
    s_add_u32 s62, s62, s64
    s_lshl_b32 s74, s8, 5
    buffer_load_dwordx4 v[48:51], v1, s[48:51], s62 offen offset:0 nt
    buffer_load_dwordx4 v[52:55], v1, s[48:51], s62 offen offset:128 nt
    buffer_load_dwordx4 v[56:59], v1, s[48:51], s62 offen offset:256 nt
    v_add_f32 v2, v2, v3
    v_add_f32 v2, v2, v4
    s_nop 1
    v_add_f32_dpp v2, v2, v2 quad_perm:[1,0,3,2] row_mask:0xf bank_mask:0xf
    s_nop 1
    v_add_f32_dpp v2, v2, v2 quad_perm:[2,3,0,1] row_mask:0xf bank_mask:0xf
    s_nop 1
    v_add_f32_dpp v2, v2, v2 row_half_mirror row_mask:0xf bank_mask:0xf
    v_cvt_pk_bf16_f32 v2, v2, v2
    v_and_b32 v2, s7, v2
    v_mul_f32 v2, s43, v2
    v_cvt_pk_bf16_f32 v2, v2, v2
    v_and_b32 v2, s7, v2
    v_min_u32 v2, -2, v2
    ds_write_b32 v9, v2 offset:0
    s_waitcnt vmcnt(3)
    v_add_u32 v9, s75, v8
    v_mov_b32 v2, 0
    v_mov_b32 v3, 0
    v_mov_b32 v4, 0
    v_dot2c_f32_bf16 v2, v60, v10
    v_dot2c_f32_bf16 v3, v64, v14
    v_dot2c_f32_bf16 v4, v68, v18
    v_dot2c_f32_bf16 v2, v61, v11
    v_dot2c_f32_bf16 v3, v65, v15
    v_dot2c_f32_bf16 v4, v69, v19
    v_dot2c_f32_bf16 v2, v62, v12
    v_dot2c_f32_bf16 v3, v66, v16
    v_dot2c_f32_bf16 v4, v70, v20
    v_dot2c_f32_bf16 v2, v63, v13
    v_dot2c_f32_bf16 v3, v67, v17
    v_dot2c_f32_bf16 v4, v71, v21
    s_add_u32 s8, s3, 4
    s_mul_i32 s62, s8, 3072
    s_add_u32 s62, s62, s64
    s_lshl_b32 s75, s8, 5
    buffer_load_dwordx4 v[60:63], v1, s[48:51], s62 offen offset:0 nt
    buffer_load_dwordx4 v[64:67], v1, s[48:51], s62 offen offset:128 nt
    buffer_load_dwordx4 v[68:71], v1, s[48:51], s62 offen offset:256 nt
    s_mov_b64 exec, 1
    ds_add_rtn_u32 v126, v124, v125 offset:548
    s_mov_b64 exec, -1
    v_add_f32 v2, v2, v3
    v_add_f32 v2, v2, v4
    s_nop 1
    v_add_f32_dpp v2, v2, v2 quad_perm:[1,0,3,2] row_mask:0xf bank_mask:0xf
    s_nop 1
    v_add_f32_dpp v2, v2, v2 quad_perm:[2,3,0,1] row_mask:0xf bank_mask:0xf
    s_nop 1
    v_add_f32_dpp v2, v2, v2 row_half_mirror row_mask:0xf bank_mask:0xf
    v_cvt_pk_bf16_f32 v2, v2, v2
    v_and_b32 v2, s7, v2
    v_mul_f32 v2, s43, v2
    v_cvt_pk_bf16_f32 v2, v2, v2
    v_and_b32 v2, s7, v2
    v_min_u32 v2, -2, v2
    ds_write_b32 v9, v2 offset:0
    s_branch L_v0
L_kend1:
    s_add_u32 s8, s3, -4
    s_mul_i32 s62, s8, 3072
    s_add_u32 s62, s62, s64
    s_lshl_b32 s75, s8, 5
    buffer_load_dwordx4 v[60:63], v1, s[48:51], s62 offen offset:0 nt
    buffer_load_dwordx4 v[64:67], v1, s[48:51], s62 offen offset:128 nt
    buffer_load_dwordx4 v[68:71], v1, s[48:51], s62 offen offset:256 nt
    v_add_f32 v2, v2, v3
    v_add_f32 v2, v2, v4
    s_nop 1
    v_add_f32_dpp v2, v2, v2 quad_perm:[1,0,3,2] row_mask:0xf bank_mask:0xf
    s_nop 1
    v_add_f32_dpp v2, v2, v2 quad_perm:[2,3,0,1] row_mask:0xf bank_mask:0xf
    s_nop 1
    v_add_f32_dpp v2, v2, v2 row_half_mirror row_mask:0xf bank_mask:0xf
    v_cvt_pk_bf16_f32 v2, v2, v2
    v_and_b32 v2, s7, v2
    v_mul_f32 v2, s43, v2
    v_cvt_pk_bf16_f32 v2, v2, v2
    v_and_b32 v2, s7, v2
    v_min_u32 v2, -2, v2
    ds_write_b32 v9, v2 offset:0
    s_waitcnt vmcnt(3)
    v_add_u32 v9, s74, v8
    v_mov_b32 v2, 0
    v_mov_b32 v3, 0
    v_mov_b32 v4, 0
    v_dot2c_f32_bf16 v2, v48, v10
    v_dot2c_f32_bf16 v3, v52, v14
    v_dot2c_f32_bf16 v4, v56, v18
    v_dot2c_f32_bf16 v2, v49, v11
    v_dot2c_f32_bf16 v3, v53, v15
    v_dot2c_f32_bf16 v4, v57, v19
    v_dot2c_f32_bf16 v2, v50, v12
    v_dot2c_f32_bf16 v3, v54, v16
    v_dot2c_f32_bf16 v4, v58, v20
    v_dot2c_f32_bf16 v2, v51, v13
    v_dot2c_f32_bf16 v3, v55, v17
    v_dot2c_f32_bf16 v4, v59, v21
    s_add_u32 s8, s3, 4
    s_mul_i32 s62, s8, 3072
    s_add_u32 s62, s62, s64
    s_lshl_b32 s74, s8, 5
    buffer_load_dwordx4 v[48:51], v1, s[48:51], s62 offen offset:0 nt
    buffer_load_dwordx4 v[52:55], v1, s[48:51], s62 offen offset:128 nt
    buffer_load_dwordx4 v[56:59], v1, s[48:51], s62 offen offset:256 nt
    s_mov_b64 exec, 1
    ds_add_rtn_u32 v126, v124, v125 offset:548
    s_mov_b64 exec, -1
    v_add_f32 v2, v2, v3
    v_add_f32 v2, v2, v4
    s_nop 1
    v_add_f32_dpp v2, v2, v2 quad_perm:[1,0,3,2] row_mask:0xf bank_mask:0xf
    s_nop 1
    v_add_f32_dpp v2, v2, v2 quad_perm:[2,3,0,1] row_mask:0xf bank_mask:0xf
    s_nop 1
    v_add_f32_dpp v2, v2, v2 row_half_mirror row_mask:0xf bank_mask:0xf
    v_cvt_pk_bf16_f32 v2, v2, v2
    v_and_b32 v2, s7, v2
    v_mul_f32 v2, s43, v2
    v_cvt_pk_bf16_f32 v2, v2, v2
    v_and_b32 v2, s7, v2
    v_min_u32 v2, -2, v2
    ds_write_b32 v9, v2 offset:0
    s_branch L_v1
L_v0:
    v_add_u32 v9, s74, v8
SC_5:
    ds_read_b32 v2, v9
    s_waitcnt lgkmcnt(0)
    v_cmp_eq_u32 vcc, -1, v2
    s_cbranch_vccnz SC_5_again
    v_max_f32 v3, v22, v2
    v_sub_f32 v4, v22, v3
    v_sub_f32 v5, v2, v3
    v_mul_f32 v4, s42, v4
    v_mul_f32 v5, s42, v5
    v_exp_f32 v122, v4
    v_exp_f32 v6, v5
    v_mov_b32 v22, v3
    v_fma_f32 v23, v23, v122, v6
    v_pk_mul_f32 v[24:25], v[24:25], v[122:123] op_sel_hi:[1,0]
    v_pk_mul_f32 v[26:27], v[26:27], v[122:123] op_sel_hi:[1,0]
    v_pk_mul_f32 v[28:29], v[28:29], v[122:123] op_sel_hi:[1,0]
    v_pk_mul_f32 v[30:31], v[30:31], v[122:123] op_sel_hi:[1,0]
    v_pk_mul_f32 v[32:33], v[32:33], v[122:123] op_sel_hi:[1,0]
    v_pk_mul_f32 v[34:35], v[34:35], v[122:123] op_sel_hi:[1,0]
    v_pk_mul_f32 v[36:37], v[36:37], v[122:123] op_sel_hi:[1,0]
    v_pk_mul_f32 v[38:39], v[38:39], v[122:123] op_sel_hi:[1,0]
    v_pk_mul_f32 v[40:41], v[40:41], v[122:123] op_sel_hi:[1,0]
    v_pk_mul_f32 v[42:43], v[42:43], v[122:123] op_sel_hi:[1,0]
    v_pk_mul_f32 v[44:45], v[44:45], v[122:123] op_sel_hi:[1,0]
    v_pk_mul_f32 v[46:47], v[46:47], v[122:123] op_sel_hi:[1,0]
    s_waitcnt vmcnt(3)
    v_lshlrev_b32 v120, 16, v48
    v_and_b32 v121, s7, v48
    v_pk_fma_f32 v[24:25], v[120:121], v[6:7], v[24:25] op_sel_hi:[1,0,1]
    v_lshlrev_b32 v122, 16, v49
    v_and_b32 v123, s7, v49
    v_pk_fma_f32 v[26:27], v[122:123], v[6:7], v[26:27] op_sel_hi:[1,0,1]
    v_lshlrev_b32 v120, 16, v50
    v_and_b32 v121, s7, v50
    v_pk_fma_f32 v[28:29], v[120:121], v[6:7], v[28:29] op_sel_hi:[1,0,1]
    v_lshlrev_b32 v122, 16, v51
    v_and_b32 v123, s7, v51
    v_pk_fma_f32 v[30:31], v[122:123], v[6:7], v[30:31] op_sel_hi:[1,0,1]
    v_lshlrev_b32 v120, 16, v52
    v_and_b32 v121, s7, v52
    v_pk_fma_f32 v[32:33], v[120:121], v[6:7], v[32:33] op_sel_hi:[1,0,1]
    v_lshlrev_b32 v122, 16, v53
    v_and_b32 v123, s7, v53
    v_pk_fma_f32 v[34:35], v[122:123], v[6:7], v[34:35] op_sel_hi:[1,0,1]
    v_lshlrev_b32 v120, 16, v54
    v_and_b32 v121, s7, v54
    v_pk_fma_f32 v[36:37], v[120:121], v[6:7], v[36:37] op_sel_hi:[1,0,1]
    v_lshlrev_b32 v122, 16, v55
    v_and_b32 v123, s7, v55
    v_pk_fma_f32 v[38:39], v[122:123], v[6:7], v[38:39] op_sel_hi:[1,0,1]
    v_lshlrev_b32 v120, 16, v56
    v_and_b32 v121, s7, v56
    v_pk_fma_f32 v[40:41], v[120:121], v[6:7], v[40:41] op_sel_hi:[1,0,1]
    v_lshlrev_b32 v122, 16, v57
    v_and_b32 v123, s7, v57
    v_pk_fma_f32 v[42:43], v[122:123], v[6:7], v[42:43] op_sel_hi:[1,0,1]
    v_lshlrev_b32 v120, 16, v58
    v_and_b32 v121, s7, v58
    v_pk_fma_f32 v[44:45], v[120:121], v[6:7], v[44:45] op_sel_hi:[1,0,1]
    v_lshlrev_b32 v122, 16, v59
    v_and_b32 v123, s7, v59
    v_pk_fma_f32 v[46:47], v[122:123], v[6:7], v[46:47] op_sel_hi:[1,0,1]
    s_waitcnt lgkmcnt(0)
    v_readfirstlane_b32 s8, v126
    s_nop 0
    s_cmp_ge_u32 s8, s65
    s_cbranch_scc1 L_vend0
    s_mul_i32 s62, s8, 3072
    s_add_u32 s62, s62, s64
    s_lshl_b32 s74, s8, 5
    buffer_load_dwordx4 v[48:51], v1, s[48:51], s62 offen offset:0 nt
    buffer_load_dwordx4 v[52:55], v1, s[48:51], s62 offen offset:128 nt
    buffer_load_dwordx4 v[56:59], v1, s[48:51], s62 offen offset:256 nt
    s_mov_b64 exec, 1
    ds_add_rtn_u32 v126, v124, v125 offset:548
    s_mov_b64 exec, -1
L_v1:
    v_add_u32 v9, s75, v8
SC_6:
    ds_read_b32 v2, v9
    s_waitcnt lgkmcnt(0)
    v_cmp_eq_u32 vcc, -1, v2
    s_cbranch_vccnz SC_6_again
    v_max_f32 v3, v22, v2
    v_sub_f32 v4, v22, v3
    v_sub_f32 v5, v2, v3
    v_mul_f32 v4, s42, v4
    v_mul_f32 v5, s42, v5
    v_exp_f32 v122, v4
    v_exp_f32 v6, v5
    v_mov_b32 v22, v3
    v_fma_f32 v23, v23, v122, v6
    v_pk_mul_f32 v[24:25], v[24:25], v[122:123] op_sel_hi:[1,0]
    v_pk_mul_f32 v[26:27], v[26:27], v[122:123] op_sel_hi:[1,0]
    v_pk_mul_f32 v[28:29], v[28:29], v[122:123] op_sel_hi:[1,0]
    v_pk_mul_f32 v[30:31], v[30:31], v[122:123] op_sel_hi:[1,0]
    v_pk_mul_f32 v[32:33], v[32:33], v[122:123] op_sel_hi:[1,0]
    v_pk_mul_f32 v[34:35], v[34:35], v[122:123] op_sel_hi:[1,0]
    v_pk_mul_f32 v[36:37], v[36:37], v[122:123] op_sel_hi:[1,0]
    v_pk_mul_f32 v[38:39], v[38:39], v[122:123] op_sel_hi:[1,0]
    v_pk_mul_f32 v[40:41], v[40:41], v[122:123] op_sel_hi:[1,0]
    v_pk_mul_f32 v[42:43], v[42:43], v[122:123] op_sel_hi:[1,0]
    v_pk_mul_f32 v[44:45], v[44:45], v[122:123] op_sel_hi:[1,0]
    v_pk_mul_f32 v[46:47], v[46:47], v[122:123] op_sel_hi:[1,0]
    s_waitcnt vmcnt(3)
    v_lshlrev_b32 v120, 16, v60
    v_and_b32 v121, s7, v60
    v_pk_fma_f32 v[24:25], v[120:121], v[6:7], v[24:25] op_sel_hi:[1,0,1]
    v_lshlrev_b32 v122, 16, v61
    v_and_b32 v123, s7, v61
    v_pk_fma_f32 v[26:27], v[122:123], v[6:7], v[26:27] op_sel_hi:[1,0,1]
    v_lshlrev_b32 v120, 16, v62
    v_and_b32 v121, s7, v62
    v_pk_fma_f32 v[28:29], v[120:121], v[6:7], v[28:29] op_sel_hi:[1,0,1]
    v_lshlrev_b32 v122, 16, v63
    v_and_b32 v123, s7, v63
    v_pk_fma_f32 v[30:31], v[122:123], v[6:7], v[30:31] op_sel_hi:[1,0,1]
    v_lshlrev_b32 v120, 16, v64
    v_and_b32 v121, s7, v64
    v_pk_fma_f32 v[32:33], v[120:121], v[6:7], v[32:33] op_sel_hi:[1,0,1]
    v_lshlrev_b32 v122, 16, v65
    v_and_b32 v123, s7, v65
    v_pk_fma_f32 v[34:35], v[122:123], v[6:7], v[34:35] op_sel_hi:[1,0,1]
    v_lshlrev_b32 v120, 16, v66
    v_and_b32 v121, s7, v66
    v_pk_fma_f32 v[36:37], v[120:121], v[6:7], v[36:37] op_sel_hi:[1,0,1]
    v_lshlrev_b32 v122, 16, v67
    v_and_b32 v123, s7, v67
    v_pk_fma_f32 v[38:39], v[122:123], v[6:7], v[38:39] op_sel_hi:[1,0,1]
    v_lshlrev_b32 v120, 16, v68
    v_and_b32 v121, s7, v68
    v_pk_fma_f32 v[40:41], v[120:121], v[6:7], v[40:41] op_sel_hi:[1,0,1]
    v_lshlrev_b32 v122, 16, v69
    v_and_b32 v123, s7, v69
    v_pk_fma_f32 v[42:43], v[122:123], v[6:7], v[42:43] op_sel_hi:[1,0,1]
    v_lshlrev_b32 v120, 16, v70
    v_and_b32 v121, s7, v70
    v_pk_fma_f32 v[44:45], v[120:121], v[6:7], v[44:45] op_sel_hi:[1,0,1]
    v_lshlrev_b32 v122, 16, v71
    v_and_b32 v123, s7, v71
    v_pk_fma_f32 v[46:47], v[122:123], v[6:7], v[46:47] op_sel_hi:[1,0,1]
    s_waitcnt lgkmcnt(0)
    v_readfirstlane_b32 s8, v126
    s_nop 0
    s_cmp_ge_u32 s8, s65
    s_cbranch_scc1 L_vend1
    s_mul_i32 s62, s8, 3072
    s_add_u32 s62, s62, s64
    s_lshl_b32 s75, s8, 5
    buffer_load_dwordx4 v[60:63], v1, s[48:51], s62 offen offset:0 nt
    buffer_load_dwordx4 v[64:67], v1, s[48:51], s62 offen offset:128 nt
    buffer_load_dwordx4 v[68:71], v1, s[48:51], s62 offen offset:256 nt
    s_mov_b64 exec, 1
    ds_add_rtn_u32 v126, v124, v125 offset:548
    s_mov_b64 exec, -1
    s_branch L_v0
L_vend1:
    s_mov_b32 s8, 1
    s_atomic_add s8, s[60:61], 0 glc
    s_waitcnt lgkmcnt(0)
    s_add_u32 s8, s8, 1748
    s_cmp_ge_u32 s8, 2048
    s_cbranch_scc1 L_vnoneA
    s_mul_i32 s62, s8, 3072
    v_add_u32 v9, s74, v8
SC_7:
    ds_read_b32 v2, v9
    s_waitcnt lgkmcnt(0)
    v_cmp_eq_u32 vcc, -1, v2
    s_cbranch_vccnz SC_7_again
    v_max_f32 v3, v22, v2
    v_sub_f32 v4, v22, v3
    v_sub_f32 v5, v2, v3
    v_mul_f32 v4, s42, v4
    v_mul_f32 v5, s42, v5
    v_exp_f32 v122, v4
    v_exp_f32 v6, v5
    v_mov_b32 v22, v3
    v_fma_f32 v23, v23, v122, v6
    v_pk_mul_f32 v[24:25], v[24:25], v[122:123] op_sel_hi:[1,0]
    v_pk_mul_f32 v[26:27], v[26:27], v[122:123] op_sel_hi:[1,0]
    v_pk_mul_f32 v[28:29], v[28:29], v[122:123] op_sel_hi:[1,0]
    v_pk_mul_f32 v[30:31], v[30:31], v[122:123] op_sel_hi:[1,0]
    v_pk_mul_f32 v[32:33], v[32:33], v[122:123] op_sel_hi:[1,0]
    v_pk_mul_f32 v[34:35], v[34:35], v[122:123] op_sel_hi:[1,0]
    v_pk_mul_f32 v[36:37], v[36:37], v[122:123] op_sel_hi:[1,0]
    v_pk_mul_f32 v[38:39], v[38:39], v[122:123] op_sel_hi:[1,0]
    v_pk_mul_f32 v[40:41], v[40:41], v[122:123] op_sel_hi:[1,0]
    v_pk_mul_f32 v[42:43], v[42:43], v[122:123] op_sel_hi:[1,0]
    v_pk_mul_f32 v[44:45], v[44:45], v[122:123] op_sel_hi:[1,0]
    v_pk_mul_f32 v[46:47], v[46:47], v[122:123] op_sel_hi:[1,0]
    s_waitcnt vmcnt(0)
    v_lshlrev_b32 v120, 16, v48
    v_and_b32 v121, s7, v48
    v_pk_fma_f32 v[24:25], v[120:121], v[6:7], v[24:25] op_sel_hi:[1,0,1]
    v_lshlrev_b32 v122, 16, v49
    v_and_b32 v123, s7, v49
    v_pk_fma_f32 v[26:27], v[122:123], v[6:7], v[26:27] op_sel_hi:[1,0,1]
    v_lshlrev_b32 v120, 16, v50
    v_and_b32 v121, s7, v50
    v_pk_fma_f32 v[28:29], v[120:121], v[6:7], v[28:29] op_sel_hi:[1,0,1]
    v_lshlrev_b32 v122, 16, v51
    v_and_b32 v123, s7, v51
    v_pk_fma_f32 v[30:31], v[122:123], v[6:7], v[30:31] op_sel_hi:[1,0,1]
    v_lshlrev_b32 v120, 16, v52
    v_and_b32 v121, s7, v52
    v_pk_fma_f32 v[32:33], v[120:121], v[6:7], v[32:33] op_sel_hi:[1,0,1]
    v_lshlrev_b32 v122, 16, v53
    v_and_b32 v123, s7, v53
    v_pk_fma_f32 v[34:35], v[122:123], v[6:7], v[34:35] op_sel_hi:[1,0,1]
    v_lshlrev_b32 v120, 16, v54
    v_and_b32 v121, s7, v54
    v_pk_fma_f32 v[36:37], v[120:121], v[6:7], v[36:37] op_sel_hi:[1,0,1]
    v_lshlrev_b32 v122, 16, v55
    v_and_b32 v123, s7, v55
    v_pk_fma_f32 v[38:39], v[122:123], v[6:7], v[38:39] op_sel_hi:[1,0,1]
    v_lshlrev_b32 v120, 16, v56
    v_and_b32 v121, s7, v56
    v_pk_fma_f32 v[40:41], v[120:121], v[6:7], v[40:41] op_sel_hi:[1,0,1]
    v_lshlrev_b32 v122, 16, v57
    v_and_b32 v123, s7, v57
    v_pk_fma_f32 v[42:43], v[122:123], v[6:7], v[42:43] op_sel_hi:[1,0,1]
    v_lshlrev_b32 v120, 16, v58
    v_and_b32 v121, s7, v58
    v_pk_fma_f32 v[44:45], v[120:121], v[6:7], v[44:45] op_sel_hi:[1,0,1]
    v_lshlrev_b32 v122, 16, v59
    v_and_b32 v123, s7, v59
    v_pk_fma_f32 v[46:47], v[122:123], v[6:7], v[46:47] op_sel_hi:[1,0,1]
    s_mov_b64 exec, 1
    global_atomic_add v127, v124, v125, s[60:61] sc0
    s_mov_b64 exec, -1
    buffer_load_dwordx4 v[48:51], v1, s[44:47], s62 offen offset:0 nt
    buffer_load_dwordx4 v[52:55], v1, s[44:47], s62 offen offset:128 nt
    buffer_load_dwordx4 v[56:59], v1, s[44:47], s62 offen offset:256 nt
    buffer_load_dwordx4 v[60:63], v1, s[48:51], s62 offen offset:0 nt
    buffer_load_dwordx4 v[64:67], v1, s[48:51], s62 offen offset:128 nt
    buffer_load_dwordx4 v[68:71], v1, s[48:51], s62 offen offset:256 nt
    s_branch L_loop
L_vend0:
    s_mov_b32 s8, 1
    s_atomic_add s8, s[60:61], 0 glc
    s_waitcnt lgkmcnt(0)
    s_add_u32 s8, s8, 1748
    s_cmp_ge_u32 s8, 2048
    s_cbranch_scc1 L_vnoneB
    s_mul_i32 s62, s8, 3072
    s_mov_b64 exec, 1
    global_atomic_add v127, v124, v125, s[60:61] sc0
    s_mov_b64 exec, -1
    buffer_load_dwordx4 v[48:51], v1, s[44:47], s62 offen offset:0 nt
    buffer_load_dwordx4 v[52:55], v1, s[44:47], s62 offen offset:128 nt
    buffer_load_dwordx4 v[56:59], v1, s[44:47], s62 offen offset:256 nt
    v_add_u32 v9, s75, v8
SC_8:
    ds_read_b32 v2, v9
    s_waitcnt lgkmcnt(0)
    v_cmp_eq_u32 vcc, -1, v2
    s_cbranch_vccnz SC_8_again
    v_max_f32 v3, v22, v2
    v_sub_f32 v4, v22, v3
    v_sub_f32 v5, v2, v3
    v_mul_f32 v4, s42, v4
    v_mul_f32 v5, s42, v5
    v_exp_f32 v122, v4
    v_exp_f32 v6, v5
    v_mov_b32 v22, v3
    v_fma_f32 v23, v23, v122, v6
    v_pk_mul_f32 v[24:25], v[24:25], v[122:123] op_sel_hi:[1,0]
    v_pk_mul_f32 v[26:27], v[26:27], v[122:123] op_sel_hi:[1,0]
    v_pk_mul_f32 v[28:29], v[28:29], v[122:123] op_sel_hi:[1,0]
    v_pk_mul_f32 v[30:31], v[30:31], v[122:123] op_sel_hi:[1,0]
    v_pk_mul_f32 v[32:33], v[32:33], v[122:123] op_sel_hi:[1,0]
    v_pk_mul_f32 v[34:35], v[34:35], v[122:123] op_sel_hi:[1,0]
    v_pk_mul_f32 v[36:37], v[36:37], v[122:123] op_sel_hi:[1,0]
    v_pk_mul_f32 v[38:39], v[38:39], v[122:123] op_sel_hi:[1,0]
    v_pk_mul_f32 v[40:41], v[40:41], v[122:123] op_sel_hi:[1,0]
    v_pk_mul_f32 v[42:43], v[42:43], v[122:123] op_sel_hi:[1,0]
    v_pk_mul_f32 v[44:45], v[44:45], v[122:123] op_sel_hi:[1,0]
    v_pk_mul_f32 v[46:47], v[46:47], v[122:123] op_sel_hi:[1,0]
    s_waitcnt vmcnt(4)
    v_lshlrev_b32 v120, 16, v60
    v_and_b32 v121, s7, v60
    v_pk_fma_f32 v[24:25], v[120:121], v[6:7], v[24:25] op_sel_hi:[1,0,1]
    v_lshlrev_b32 v122, 16, v61
    v_and_b32 v123, s7, v61
    v_pk_fma_f32 v[26:27], v[122:123], v[6:7], v[26:27] op_sel_hi:[1,0,1]
    v_lshlrev_b32 v120, 16, v62
    v_and_b32 v121, s7, v62
    v_pk_fma_f32 v[28:29], v[120:121], v[6:7], v[28:29] op_sel_hi:[1,0,1]
    v_lshlrev_b32 v122, 16, v63
    v_and_b32 v123, s7, v63
    v_pk_fma_f32 v[30:31], v[122:123], v[6:7], v[30:31] op_sel_hi:[1,0,1]
    v_lshlrev_b32 v120, 16, v64
    v_and_b32 v121, s7, v64
    v_pk_fma_f32 v[32:33], v[120:121], v[6:7], v[32:33] op_sel_hi:[1,0,1]
    v_lshlrev_b32 v122, 16, v65
    v_and_b32 v123, s7, v65
    v_pk_fma_f32 v[34:35], v[122:123], v[6:7], v[34:35] op_sel_hi:[1,0,1]
    v_lshlrev_b32 v120, 16, v66
    v_and_b32 v121, s7, v66
    v_pk_fma_f32 v[36:37], v[120:121], v[6:7], v[36:37] op_sel_hi:[1,0,1]
    v_lshlrev_b32 v122, 16, v67
    v_and_b32 v123, s7, v67
    v_pk_fma_f32 v[38:39], v[122:123], v[6:7], v[38:39] op_sel_hi:[1,0,1]
    v_lshlrev_b32 v120, 16, v68
    v_and_b32 v121, s7, v68
    v_pk_fma_f32 v[40:41], v[120:121], v[6:7], v[40:41] op_sel_hi:[1,0,1]
    v_lshlrev_b32 v122, 16, v69
    v_and_b32 v123, s7, v69
    v_pk_fma_f32 v[42:43], v[122:123], v[6:7], v[42:43] op_sel_hi:[1,0,1]
    v_lshlrev_b32 v120, 16, v70
    v_and_b32 v121, s7, v70
    v_pk_fma_f32 v[44:45], v[120:121], v[6:7], v[44:45] op_sel_hi:[1,0,1]
    v_lshlrev_b32 v122, 16, v71
    v_and_b32 v123, s7, v71
    v_pk_fma_f32 v[46:47], v[122:123], v[6:7], v[46:47] op_sel_hi:[1,0,1]
    buffer_load_dwordx4 v[60:63], v1, s[48:51], s62 offen offset:0 nt
    buffer_load_dwordx4 v[64:67], v1, s[48:51], s62 offen offset:128 nt
    buffer_load_dwordx4 v[68:71], v1, s[48:51], s62 offen offset:256 nt
L_loop:
    s_waitcnt vmcnt(3)
    v_readfirstlane_b32 s8, v127
    v_mov_b32 v2, 0
    v_mov_b32 v3, 0
    v_mov_b32 v4, 0
    v_dot2c_f32_bf16 v2, v48, v10
    v_dot2c_f32_bf16 v3, v52, v14
    v_dot2c_f32_bf16 v4, v56, v18
    v_dot2c_f32_bf16 v2, v49, v11
    v_dot2c_f32_bf16 v3, v53, v15
    v_dot2c_f32_bf16 v4, v57, v19
    v_dot2c_f32_bf16 v2, v50, v12
    v_dot2c_f32_bf16 v3, v54, v16
    v_dot2c_f32_bf16 v4, v58, v20
    v_dot2c_f32_bf16 v2, v51, v13
    v_dot2c_f32_bf16 v3, v55, v17
    v_dot2c_f32_bf16 v4, v59, v21
    s_add_u32 s8, s8, 1748
    s_cmp_ge_u32 s8, 2048
    s_cbranch_scc1 L_drain
    s_mul_i32 s62, s8, 3072
    s_mov_b64 exec, 1
    global_atomic_add v127, v124, v125, s[60:61] sc0
    s_mov_b64 exec, -1
    buffer_load_dwordx4 v[48:51], v1, s[44:47], s62 offen offset:0 nt
    buffer_load_dwordx4 v[52:55], v1, s[44:47], s62 offen offset:128 nt
    buffer_load_dwordx4 v[56:59], v1, s[44:47], s62 offen offset:256 nt
    v_add_f32 v2, v2, v3
    v_add_f32 v2, v2, v4
    s_nop 1
    v_add_f32_dpp v2, v2, v2 quad_perm:[1,0,3,2] row_mask:0xf bank_mask:0xf
    s_nop 1
    v_add_f32_dpp v2, v2, v2 quad_perm:[2,3,0,1] row_mask:0xf bank_mask:0xf
    s_nop 1
    v_add_f32_dpp v2, v2, v2 row_half_mirror row_mask:0xf bank_mask:0xf
    v_cvt_pk_bf16_f32 v2, v2, v2
    v_and_b32 v2, s7, v2
    v_mul_f32 v2, s43, v2
    v_cvt_pk_bf16_f32 v2, v2, v2
    v_and_b32 v2, s7, v2
    v_max_f32 v3, v22, v2
    v_sub_f32 v4, v22, v3
    v_sub_f32 v5, v2, v3
    v_mul_f32 v4, s42, v4
    v_mul_f32 v5, s42, v5
    v_exp_f32 v122, v4
    v_exp_f32 v6, v5
    v_mov_b32 v22, v3
    v_fma_f32 v23, v23, v122, v6
    v_pk_mul_f32 v[24:25], v[24:25], v[122:123] op_sel_hi:[1,0]
    v_pk_mul_f32 v[26:27], v[26:27], v[122:123] op_sel_hi:[1,0]
    v_pk_mul_f32 v[28:29], v[28:29], v[122:123] op_sel_hi:[1,0]
    v_pk_mul_f32 v[30:31], v[30:31], v[122:123] op_sel_hi:[1,0]
    v_pk_mul_f32 v[32:33], v[32:33], v[122:123] op_sel_hi:[1,0]
    v_pk_mul_f32 v[34:35], v[34:35], v[122:123] op_sel_hi:[1,0]
    v_pk_mul_f32 v[36:37], v[36:37], v[122:123] op_sel_hi:[1,0]
    v_pk_mul_f32 v[38:39], v[38:39], v[122:123] op_sel_hi:[1,0]
    v_pk_mul_f32 v[40:41], v[40:41], v[122:123] op_sel_hi:[1,0]
    v_pk_mul_f32 v[42:43], v[42:43], v[122:123] op_sel_hi:[1,0]
    v_pk_mul_f32 v[44:45], v[44:45], v[122:123] op_sel_hi:[1,0]
    v_pk_mul_f32 v[46:47], v[46:47], v[122:123] op_sel_hi:[1,0]
    s_waitcnt vmcnt(4)
    v_lshlrev_b32 v120, 16, v60
    v_and_b32 v121, s7, v60
    v_pk_fma_f32 v[24:25], v[120:121], v[6:7], v[24:25] op_sel_hi:[1,0,1]
    v_lshlrev_b32 v122, 16, v61
    v_and_b32 v123, s7, v61
    v_pk_fma_f32 v[26:27], v[122:123], v[6:7], v[26:27] op_sel_hi:[1,0,1]
    v_lshlrev_b32 v120, 16, v62
    v_and_b32 v121, s7, v62
    v_pk_fma_f32 v[28:29], v[120:121], v[6:7], v[28:29] op_sel_hi:[1,0,1]
    v_lshlrev_b32 v122, 16, v63
    v_and_b32 v123, s7, v63
    v_pk_fma_f32 v[30:31], v[122:123], v[6:7], v[30:31] op_sel_hi:[1,0,1]
    v_lshlrev_b32 v120, 16, v64
    v_and_b32 v121, s7, v64
    v_pk_fma_f32 v[32:33], v[120:121], v[6:7], v[32:33] op_sel_hi:[1,0,1]
    v_lshlrev_b32 v122, 16, v65
    v_and_b32 v123, s7, v65
    v_pk_fma_f32 v[34:35], v[122:123], v[6:7], v[34:35] op_sel_hi:[1,0,1]
    v_lshlrev_b32 v120, 16, v66
    v_and_b32 v121, s7, v66
    v_pk_fma_f32 v[36:37], v[120:121], v[6:7], v[36:37] op_sel_hi:[1,0,1]
    v_lshlrev_b32 v122, 16, v67
    v_and_b32 v123, s7, v67
    v_pk_fma_f32 v[38:39], v[122:123], v[6:7], v[38:39] op_sel_hi:[1,0,1]
    v_lshlrev_b32 v120, 16, v68
    v_and_b32 v121, s7, v68
    v_pk_fma_f32 v[40:41], v[120:121], v[6:7], v[40:41] op_sel_hi:[1,0,1]
    v_lshlrev_b32 v122, 16, v69
    v_and_b32 v123, s7, v69
    v_pk_fma_f32 v[42:43], v[122:123], v[6:7], v[42:43] op_sel_hi:[1,0,1]
    v_lshlrev_b32 v120, 16, v70
    v_and_b32 v121, s7, v70
    v_pk_fma_f32 v[44:45], v[120:121], v[6:7], v[44:45] op_sel_hi:[1,0,1]
    v_lshlrev_b32 v122, 16, v71
    v_and_b32 v123, s7, v71
    v_pk_fma_f32 v[46:47], v[122:123], v[6:7], v[46:47] op_sel_hi:[1,0,1]
    buffer_load_dwordx4 v[60:63], v1, s[48:51], s62 offen offset:0 nt
    buffer_load_dwordx4 v[64:67], v1, s[48:51], s62 offen offset:128 nt
    buffer_load_dwordx4 v[68:71], v1, s[48:51], s62 offen offset:256 nt
    s_branch L_loop
L_drain:
    s_setprio 3
    v_add_f32 v2, v2, v3
    v_add_f32 v2, v2, v4
    s_nop 1
    v_add_f32_dpp v2, v2, v2 quad_perm:[1,0,3,2] row_mask:0xf bank_mask:0xf
    s_nop 1
    v_add_f32_dpp v2, v2, v2 quad_perm:[2,3,0,1] row_mask:0xf bank_mask:0xf
    s_nop 1
    v_add_f32_dpp v2, v2, v2 row_half_mirror row_mask:0xf bank_mask:0xf
    v_cvt_pk_bf16_f32 v2, v2, v2
    v_and_b32 v2, s7, v2
    v_mul_f32 v2, s43, v2
    v_cvt_pk_bf16_f32 v2, v2, v2
    v_and_b32 v2, s7, v2
    v_max_f32 v3, v22, v2
    s_nop 1
    v_max_f32_dpp v3, v3, v3 row_ror:8 row_mask:0xf bank_mask:0xf
    v_mov_b32 v4, v3
    s_nop 1
    v_permlane16_swap_b32 v3, v4
    v_max_f32 v3, v3, v4
    v_mov_b32 v4, v3
    s_nop 1
    v_permlane32_swap_b32 v3, v4
    v_max_f32 v3, v3, v4
    v_sub_f32 v4, v22, v3
    v_sub_f32 v5, v2, v3
    v_mul_f32 v4, s42, v4
    v_mul_f32 v5, s42, v5
    v_exp_f32 v122, v4
    v_exp_f32 v6, v5
    v_mov_b32 v22, v3
    v_fma_f32 v23, v23, v122, v6
    s_nop 1
    v_add_f32_dpp v23, v23, v23 row_ror:8 row_mask:0xf bank_mask:0xf
    v_mov_b32 v4, v23
    s_nop 1
    v_permlane16_swap_b32 v23, v4
    v_add_f32 v23, v23, v4
    v_mov_b32 v4, v23
    s_nop 1
    v_permlane32_swap_b32 v23, v4
    v_add_f32 v23, v23, v4
    s_lshl_b32 s8, s3, 3
    v_mov_b32 v4, s8
    v_mov_b32 v2, 0
    v_mov_b32 v3, 1
    s_mov_b64 exec, 1
    ds_write_b64 v4, v[22:23] offset:544
    ds_add_u32 v2, v3 offset:516
    s_mov_b64 exec, -1
    v_pk_mul_f32 v[24:25], v[24:25], v[122:123] op_sel_hi:[1,0]
    v_pk_mul_f32 v[26:27], v[26:27], v[122:123] op_sel_hi:[1,0]
    v_pk_mul_f32 v[28:29], v[28:29], v[122:123] op_sel_hi:[1,0]
    v_pk_mul_f32 v[30:31], v[30:31], v[122:123] op_sel_hi:[1,0]
    v_pk_mul_f32 v[32:33], v[32:33], v[122:123] op_sel_hi:[1,0]
    v_pk_mul_f32 v[34:35], v[34:35], v[122:123] op_sel_hi:[1,0]
    v_pk_mul_f32 v[36:37], v[36:37], v[122:123] op_sel_hi:[1,0]
    v_pk_mul_f32 v[38:39], v[38:39], v[122:123] op_sel_hi:[1,0]
    v_pk_mul_f32 v[40:41], v[40:41], v[122:123] op_sel_hi:[1,0]
    v_pk_mul_f32 v[42:43], v[42:43], v[122:123] op_sel_hi:[1,0]
    v_pk_mul_f32 v[44:45], v[44:45], v[122:123] op_sel_hi:[1,0]
    v_pk_mul_f32 v[46:47], v[46:47], v[122:123] op_sel_hi:[1,0]
L_drain2:
    v_lshrrev_b32 v52, 3, v0
    v_and_b32 v53, 7, v0
    v_mul_u32_u24 v52, 3, v52
    s_mul_i32 s8, s3, 768
    s_add_u32 s8, s8, 3840
    v_lshl_add_u32 v53, v53, 5, s8
    s_mov_b32 s12, 0xff00ff00
    s_mov_b32 s13, 0xff00ff00
    v_add_u32 v54, 0, v52
    v_lshrrev_b32 v55, 3, v54
    v_and_b32 v54, 7, v54
    v_lshl_add_u32 v55, v55, 8, v53
    v_lshl_add_u32 v48, v54, 2, v55
    v_add_u32 v54, 1, v52
    v_lshrrev_b32 v55, 3, v54
    v_and_b32 v54, 7, v54
    v_lshl_add_u32 v55, v55, 8, v53
    v_lshl_add_u32 v49, v54, 2, v55
    v_add_u32 v54, 2, v52
    v_lshrrev_b32 v55, 3, v54
    v_and_b32 v54, 7, v54
    v_lshl_add_u32 v55, v55, 8, v53
    v_lshl_add_u32 v50, v54, 2, v55
    v_mov_b32 v52, 0
    v_mov_b32 v53, 1
    s_waitcnt vmcnt(0)
    v_lshlrev_b32 v120, 16, v60
    v_and_b32 v121, s7, v60
    v_pk_fma_f32 v[24:25], v[120:121], v[6:7], v[24:25] op_sel_hi:[1,0,1]
    v_lshlrev_b32 v122, 16, v61
    v_and_b32 v123, s7, v61
    v_pk_fma_f32 v[26:27], v[122:123], v[6:7], v[26:27] op_sel_hi:[1,0,1]
    v_lshlrev_b32 v120, 16, v62
    v_and_b32 v121, s7, v62
    v_pk_fma_f32 v[28:29], v[120:121], v[6:7], v[28:29] op_sel_hi:[1,0,1]
    v_lshlrev_b32 v122, 16, v63
    v_and_b32 v123, s7, v63
    v_pk_fma_f32 v[30:31], v[122:123], v[6:7], v[30:31] op_sel_hi:[1,0,1]
    v_lshlrev_b32 v120, 16, v64
    v_and_b32 v121, s7, v64
    v_pk_fma_f32 v[32:33], v[120:121], v[6:7], v[32:33] op_sel_hi:[1,0,1]
    v_lshlrev_b32 v122, 16, v65
    v_and_b32 v123, s7, v65
    v_pk_fma_f32 v[34:35], v[122:123], v[6:7], v[34:35] op_sel_hi:[1,0,1]
    v_lshlrev_b32 v120, 16, v66
    v_and_b32 v121, s7, v66
    v_pk_fma_f32 v[36:37], v[120:121], v[6:7], v[36:37] op_sel_hi:[1,0,1]
    v_lshlrev_b32 v122, 16, v67
    v_and_b32 v123, s7, v67
    v_pk_fma_f32 v[38:39], v[122:123], v[6:7], v[38:39] op_sel_hi:[1,0,1]
    v_lshlrev_b32 v120, 16, v68
    v_and_b32 v121, s7, v68
    v_pk_fma_f32 v[40:41], v[120:121], v[6:7], v[40:41] op_sel_hi:[1,0,1]
    v_lshlrev_b32 v122, 16, v69
    v_and_b32 v123, s7, v69
    v_pk_fma_f32 v[42:43], v[122:123], v[6:7], v[42:43] op_sel_hi:[1,0,1]
    v_lshlrev_b32 v120, 16, v70
    v_and_b32 v121, s7, v70
    v_pk_fma_f32 v[44:45], v[120:121], v[6:7], v[44:45] op_sel_hi:[1,0,1]
    v_lshlrev_b32 v122, 16, v71
    v_and_b32 v123, s7, v71
    v_pk_fma_f32 v[46:47], v[122:123], v[6:7], v[46:47] op_sel_hi:[1,0,1]
L_drain3:
    v_permlane32_swap_b32 v24, v36
    v_permlane32_swap_b32 v25, v37
    v_permlane32_swap_b32 v26, v38
    v_permlane32_swap_b32 v27, v39
    v_permlane32_swap_b32 v28, v40
    v_permlane32_swap_b32 v29, v41
    v_permlane32_swap_b32 v30, v42
    v_permlane32_swap_b32 v31, v43
    v_permlane32_swap_b32 v32, v44
    v_permlane32_swap_b32 v33, v45
    v_permlane32_swap_b32 v34, v46
    v_permlane32_swap_b32 v35, v47
    v_pk_add_f32 v[24:25], v[24:25], v[36:37]
    v_pk_add_f32 v[26:27], v[26:27], v[38:39]
    v_pk_add_f32 v[28:29], v[28:29], v[40:41]
    v_pk_add_f32 v[30:31], v[30:31], v[42:43]
    v_pk_add_f32 v[32:33], v[32:33], v[44:45]
    v_pk_add_f32 v[34:35], v[34:35], v[46:47]
    v_permlane16_swap_b32 v24, v30
    v_permlane16_swap_b32 v25, v31
    v_permlane16_swap_b32 v26, v32
    v_permlane16_swap_b32 v27, v33
    v_permlane16_swap_b32 v28, v34
    v_permlane16_swap_b32 v29, v35
    v_pk_add_f32 v[24:25], v[24:25], v[30:31]
    v_pk_add_f32 v[26:27], v[26:27], v[32:33]
    v_pk_add_f32 v[28:29], v[28:29], v[34:35]
    v_add_f32_dpp v24, v24, v24 row_ror:8 row_mask:0xf bank_mask:0xf
    v_add_f32_dpp v25, v25, v25 row_ror:8 row_mask:0xf bank_mask:0xf
    v_add_f32_dpp v26, v26, v26 row_ror:8 row_mask:0xf bank_mask:0xf
    v_add_f32_dpp v27, v27, v27 row_ror:8 row_mask:0xf bank_mask:0xf
    v_add_f32_dpp v28, v28, v28 row_ror:8 row_mask:0xf bank_mask:0xf
    v_add_f32_dpp v29, v29, v29 row_ror:8 row_mask:0xf bank_mask:0xf
    v_cndmask_b32 v24, v24, v27, s[12:13]
    v_cndmask_b32 v25, v25, v28, s[12:13]
    v_cndmask_b32 v26, v26, v29, s[12:13]
    ds_write_b32 v48, v24
    ds_write_b32 v49, v25
    ds_write_b32 v50, v26
    s_mov_b64 exec, 1
    ds_add_u32 v52, v53 offset:520
    s_mov_b64 exec, -1
    s_branch L_end
L_vnoneB:
    s_setprio 3
    v_add_u32 v9, s75, v8
SC_9:
    ds_read_b32 v2, v9
    s_waitcnt lgkmcnt(0)
    v_cmp_eq_u32 vcc, -1, v2
    s_cbranch_vccnz SC_9_again
    v_max_f32 v3, v22, v2
    s_nop 1
    v_max_f32_dpp v3, v3, v3 row_ror:8 row_mask:0xf bank_mask:0xf
    v_mov_b32 v4, v3
    s_nop 1
    v_permlane16_swap_b32 v3, v4
    v_max_f32 v3, v3, v4
    v_mov_b32 v4, v3
    s_nop 1
    v_permlane32_swap_b32 v3, v4
    v_max_f32 v3, v3, v4
    v_sub_f32 v4, v22, v3
    v_sub_f32 v5, v2, v3
    v_mul_f32 v4, s42, v4
    v_mul_f32 v5, s42, v5
    v_exp_f32 v122, v4
    v_exp_f32 v6, v5
    v_mov_b32 v22, v3
    v_fma_f32 v23, v23, v122, v6
    s_nop 1
    v_add_f32_dpp v23, v23, v23 row_ror:8 row_mask:0xf bank_mask:0xf
    v_mov_b32 v4, v23
    s_nop 1
    v_permlane16_swap_b32 v23, v4
    v_add_f32 v23, v23, v4
    v_mov_b32 v4, v23
    s_nop 1
    v_permlane32_swap_b32 v23, v4
    v_add_f32 v23, v23, v4
    s_lshl_b32 s8, s3, 3
    v_mov_b32 v4, s8
    v_mov_b32 v2, 0
    v_mov_b32 v3, 1
    s_mov_b64 exec, 1
    ds_write_b64 v4, v[22:23] offset:544
    ds_add_u32 v2, v3 offset:516
    s_mov_b64 exec, -1
    v_pk_mul_f32 v[24:25], v[24:25], v[122:123] op_sel_hi:[1,0]
    v_pk_mul_f32 v[26:27], v[26:27], v[122:123] op_sel_hi:[1,0]
    v_pk_mul_f32 v[28:29], v[28:29], v[122:123] op_sel_hi:[1,0]
    v_pk_mul_f32 v[30:31], v[30:31], v[122:123] op_sel_hi:[1,0]
    v_pk_mul_f32 v[32:33], v[32:33], v[122:123] op_sel_hi:[1,0]
    v_pk_mul_f32 v[34:35], v[34:35], v[122:123] op_sel_hi:[1,0]
    v_pk_mul_f32 v[36:37], v[36:37], v[122:123] op_sel_hi:[1,0]
    v_pk_mul_f32 v[38:39], v[38:39], v[122:123] op_sel_hi:[1,0]
    v_pk_mul_f32 v[40:41], v[40:41], v[122:123] op_sel_hi:[1,0]
    v_pk_mul_f32 v[42:43], v[42:43], v[122:123] op_sel_hi:[1,0]
    v_pk_mul_f32 v[44:45], v[44:45], v[122:123] op_sel_hi:[1,0]
    v_pk_mul_f32 v[46:47], v[46:47], v[122:123] op_sel_hi:[1,0]
    s_branch L_drain2
L_vnoneA:
    s_setprio 3
    v_add_u32 v9, s74, v8
SC_10:
    ds_read_b32 v2, v9
    s_waitcnt lgkmcnt(0)
    v_cmp_eq_u32 vcc, -1, v2
    s_cbranch_vccnz SC_10_again
    v_max_f32 v3, v22, v2
    s_nop 1
    v_max_f32_dpp v3, v3, v3 row_ror:8 row_mask:0xf bank_mask:0xf
    v_mov_b32 v4, v3
    s_nop 1
    v_permlane16_swap_b32 v3, v4
    v_max_f32 v3, v3, v4
    v_mov_b32 v4, v3
    s_nop 1
    v_permlane32_swap_b32 v3, v4
    v_max_f32 v3, v3, v4
    v_sub_f32 v4, v22, v3
    v_sub_f32 v5, v2, v3
    v_mul_f32 v4, s42, v4
    v_mul_f32 v5, s42, v5
    v_exp_f32 v122, v4
    v_exp_f32 v6, v5
    v_mov_b32 v22, v3
    v_fma_f32 v23, v23, v122, v6
    s_nop 1
    v_add_f32_dpp v23, v23, v23 row_ror:8 row_mask:0xf bank_mask:0xf
    v_mov_b32 v4, v23
    s_nop 1
    v_permlane16_swap_b32 v23, v4
    v_add_f32 v23, v23, v4
    v_mov_b32 v4, v23
    s_nop 1
    v_permlane32_swap_b32 v23, v4
    v_add_f32 v23, v23, v4
    s_lshl_b32 s8, s3, 3
    v_mov_b32 v4, s8
    v_mov_b32 v2, 0
    v_mov_b32 v3, 1
    s_mov_b64 exec, 1
    ds_write_b64 v4, v[22:23] offset:544
    ds_add_u32 v2, v3 offset:516
    s_mov_b64 exec, -1
    v_pk_mul_f32 v[24:25], v[24:25], v[122:123] op_sel_hi:[1,0]
    v_pk_mul_f32 v[26:27], v[26:27], v[122:123] op_sel_hi:[1,0]
    v_pk_mul_f32 v[28:29], v[28:29], v[122:123] op_sel_hi:[1,0]
    v_pk_mul_f32 v[30:31], v[30:31], v[122:123] op_sel_hi:[1,0]
    v_pk_mul_f32 v[32:33], v[32:33], v[122:123] op_sel_hi:[1,0]
    v_pk_mul_f32 v[34:35], v[34:35], v[122:123] op_sel_hi:[1,0]
    v_pk_mul_f32 v[36:37], v[36:37], v[122:123] op_sel_hi:[1,0]
    v_pk_mul_f32 v[38:39], v[38:39], v[122:123] op_sel_hi:[1,0]
    v_pk_mul_f32 v[40:41], v[40:41], v[122:123] op_sel_hi:[1,0]
    v_pk_mul_f32 v[42:43], v[42:43], v[122:123] op_sel_hi:[1,0]
    v_pk_mul_f32 v[44:45], v[44:45], v[122:123] op_sel_hi:[1,0]
    v_pk_mul_f32 v[46:47], v[46:47], v[122:123] op_sel_hi:[1,0]
    s_waitcnt vmcnt(0)
    v_lshlrev_b32 v120, 16, v48
    v_and_b32 v121, s7, v48
    v_pk_fma_f32 v[24:25], v[120:121], v[6:7], v[24:25] op_sel_hi:[1,0,1]
    v_lshlrev_b32 v122, 16, v49
    v_and_b32 v123, s7, v49
    v_pk_fma_f32 v[26:27], v[122:123], v[6:7], v[26:27] op_sel_hi:[1,0,1]
    v_lshlrev_b32 v120, 16, v50
    v_and_b32 v121, s7, v50
    v_pk_fma_f32 v[28:29], v[120:121], v[6:7], v[28:29] op_sel_hi:[1,0,1]
    v_lshlrev_b32 v122, 16, v51
    v_and_b32 v123, s7, v51
    v_pk_fma_f32 v[30:31], v[122:123], v[6:7], v[30:31] op_sel_hi:[1,0,1]
    v_lshlrev_b32 v120, 16, v52
    v_and_b32 v121, s7, v52
    v_pk_fma_f32 v[32:33], v[120:121], v[6:7], v[32:33] op_sel_hi:[1,0,1]
    v_lshlrev_b32 v122, 16, v53
    v_and_b32 v123, s7, v53
    v_pk_fma_f32 v[34:35], v[122:123], v[6:7], v[34:35] op_sel_hi:[1,0,1]
    v_lshlrev_b32 v120, 16, v54
    v_and_b32 v121, s7, v54
    v_pk_fma_f32 v[36:37], v[120:121], v[6:7], v[36:37] op_sel_hi:[1,0,1]
    v_lshlrev_b32 v122, 16, v55
    v_and_b32 v123, s7, v55
    v_pk_fma_f32 v[38:39], v[122:123], v[6:7], v[38:39] op_sel_hi:[1,0,1]
    v_lshlrev_b32 v120, 16, v56
    v_and_b32 v121, s7, v56
    v_pk_fma_f32 v[40:41], v[120:121], v[6:7], v[40:41] op_sel_hi:[1,0,1]
    v_lshlrev_b32 v122, 16, v57
    v_and_b32 v123, s7, v57
    v_pk_fma_f32 v[42:43], v[122:123], v[6:7], v[42:43] op_sel_hi:[1,0,1]
    v_lshlrev_b32 v120, 16, v58
    v_and_b32 v121, s7, v58
    v_pk_fma_f32 v[44:45], v[120:121], v[6:7], v[44:45] op_sel_hi:[1,0,1]
    v_lshlrev_b32 v122, 16, v59
    v_and_b32 v123, s7, v59
    v_pk_fma_f32 v[46:47], v[122:123], v[6:7], v[46:47] op_sel_hi:[1,0,1]
    v_lshrrev_b32 v52, 3, v0
    v_and_b32 v53, 7, v0
    v_mul_u32_u24 v52, 3, v52
    s_mul_i32 s8, s3, 768
    s_add_u32 s8, s8, 3840
    v_lshl_add_u32 v53, v53, 5, s8
    s_mov_b32 s12, 0xff00ff00
    s_mov_b32 s13, 0xff00ff00
    v_add_u32 v54, 0, v52
    v_lshrrev_b32 v55, 3, v54
    v_and_b32 v54, 7, v54
    v_lshl_add_u32 v55, v55, 8, v53
    v_lshl_add_u32 v48, v54, 2, v55
    v_add_u32 v54, 1, v52
    v_lshrrev_b32 v55, 3, v54
    v_and_b32 v54, 7, v54
    v_lshl_add_u32 v55, v55, 8, v53
    v_lshl_add_u32 v49, v54, 2, v55
    v_add_u32 v54, 2, v52
    v_lshrrev_b32 v55, 3, v54
    v_and_b32 v54, 7, v54
    v_lshl_add_u32 v55, v55, 8, v53
    v_lshl_add_u32 v50, v54, 2, v55
    v_mov_b32 v52, 0
    v_mov_b32 v53, 1
    s_branch L_drain3
SC_5_again:
    s_add_u32 s67, s67, 1
    s_cmp_gt_u32 s67, 16000000
    s_cbranch_scc1 L_end
    s_branch SC_5
SC_6_again:
    s_add_u32 s67, s67, 1
    s_cmp_gt_u32 s67, 16000000
    s_cbranch_scc1 L_end
    s_branch SC_6
SC_7_again:
    s_add_u32 s67, s67, 1
    s_cmp_gt_u32 s67, 16000000
    s_cbranch_scc1 L_end
    s_branch SC_7
SC_8_again:
    s_add_u32 s67, s67, 1
    s_cmp_gt_u32 s67, 16000000
    s_cbranch_scc1 L_end
    s_branch SC_8
SC_9_again:
    s_add_u32 s67, s67, 1
    s_cmp_gt_u32 s67, 16000000
    s_cbranch_scc1 L_end
    s_branch SC_9
SC_10_again:
    s_add_u32 s67, s67, 1
    s_cmp_gt_u32 s67, 16000000
    s_cbranch_scc1 L_end
    s_branch SC_10
L_catch2:
    s_waitcnt vmcnt(21)
    v_mov_b32 v2, 0
    v_mov_b32 v3, 0
    v_mov_b32 v4, 0
    v_dot2c_f32_bf16 v2, v48, v10
    v_dot2c_f32_bf16 v3, v52, v14
    v_dot2c_f32_bf16 v4, v56, v18
    v_dot2c_f32_bf16 v2, v49, v11
    v_dot2c_f32_bf16 v3, v53, v15
    v_dot2c_f32_bf16 v4, v57, v19
    v_dot2c_f32_bf16 v2, v50, v12
    v_dot2c_f32_bf16 v3, v54, v16
    v_dot2c_f32_bf16 v4, v58, v20
    v_dot2c_f32_bf16 v2, v51, v13
    v_dot2c_f32_bf16 v3, v55, v17
    v_dot2c_f32_bf16 v4, v59, v21
    s_nop 1
    v_add_f32 v2, v2, v3
    v_add_f32 v2, v2, v4
    s_nop 1
    v_add_f32_dpp v2, v2, v2 quad_perm:[1,0,3,2] row_mask:0xf bank_mask:0xf
    s_nop 1
    v_add_f32_dpp v2, v2, v2 quad_perm:[2,3,0,1] row_mask:0xf bank_mask:0xf
    s_nop 1
    v_add_f32_dpp v2, v2, v2 row_half_mirror row_mask:0xf bank_mask:0xf
    v_cvt_pk_bf16_f32 v2, v2, v2
    v_and_b32 v2, s7, v2
    v_mul_f32 v2, s43, v2
    v_cvt_pk_bf16_f32 v2, v2, v2
    v_and_b32 v2, s7, v2
    v_min_u32 v2, -2, v2
    ds_write_b32 v9, v2 offset:0
    s_waitcnt vmcnt(18)
    v_mov_b32 v2, 0
    v_mov_b32 v3, 0
    v_mov_b32 v4, 0
    v_dot2c_f32_bf16 v2, v60, v10
    v_dot2c_f32_bf16 v3, v64, v14
    v_dot2c_f32_bf16 v4, v68, v18
    v_dot2c_f32_bf16 v2, v61, v11
    v_dot2c_f32_bf16 v3, v65, v15
    v_dot2c_f32_bf16 v4, v69, v19
    v_dot2c_f32_bf16 v2, v62, v12
    v_dot2c_f32_bf16 v3, v66, v16
    v_dot2c_f32_bf16 v4, v70, v20
    v_dot2c_f32_bf16 v2, v63, v13
    v_dot2c_f32_bf16 v3, v67, v17
    v_dot2c_f32_bf16 v4, v71, v21
    s_nop 1
    v_add_f32 v2, v2, v3
    v_add_f32 v2, v2, v4
    s_nop 1
    v_add_f32_dpp v2, v2, v2 quad_perm:[1,0,3,2] row_mask:0xf bank_mask:0xf
    s_nop 1
    v_add_f32_dpp v2, v2, v2 quad_perm:[2,3,0,1] row_mask:0xf bank_mask:0xf
    s_nop 1
    v_add_f32_dpp v2, v2, v2 row_half_mirror row_mask:0xf bank_mask:0xf
    v_cvt_pk_bf16_f32 v2, v2, v2
    v_and_b32 v2, s7, v2
    v_mul_f32 v2, s43, v2
    v_cvt_pk_bf16_f32 v2, v2, v2
    v_and_b32 v2, s7, v2
    v_min_u32 v2, -2, v2
    ds_write_b32 v9, v2 offset:384
    s_waitcnt vmcnt(15)
    v_mov_b32 v2, 0
    v_mov_b32 v3, 0
    v_mov_b32 v4, 0
    v_dot2c_f32_bf16 v2, v72, v10
    v_dot2c_f32_bf16 v3, v76, v14
    v_dot2c_f32_bf16 v4, v80, v18
    v_dot2c_f32_bf16 v2, v73, v11
    v_dot2c_f32_bf16 v3, v77, v15
    v_dot2c_f32_bf16 v4, v81, v19
    v_dot2c_f32_bf16 v2, v74, v12
    v_dot2c_f32_bf16 v3, v78, v16
    v_dot2c_f32_bf16 v4, v82, v20
    v_dot2c_f32_bf16 v2, v75, v13
    v_dot2c_f32_bf16 v3, v79, v17
    v_dot2c_f32_bf16 v4, v83, v21
    s_nop 1
    v_add_f32 v2, v2, v3
    v_add_f32 v2, v2, v4
    s_nop 1
    v_add_f32_dpp v2, v2, v2 quad_perm:[1,0,3,2] row_mask:0xf bank_mask:0xf
    s_nop 1
    v_add_f32_dpp v2, v2, v2 quad_perm:[2,3,0,1] row_mask:0xf bank_mask:0xf
    s_nop 1
    v_add_f32_dpp v2, v2, v2 row_half_mirror row_mask:0xf bank_mask:0xf
    v_cvt_pk_bf16_f32 v2, v2, v2
    v_and_b32 v2, s7, v2
    v_mul_f32 v2, s43, v2
    v_cvt_pk_bf16_f32 v2, v2, v2
    v_and_b32 v2, s7, v2
    v_min_u32 v2, -2, v2
    ds_write_b32 v9, v2 offset:768
    s_waitcnt vmcnt(12)
    v_mov_b32 v2, 0
    v_mov_b32 v3, 0
    v_mov_b32 v4, 0
    v_dot2c_f32_bf16 v2, v84, v10
    v_dot2c_f32_bf16 v3, v88, v14
    v_dot2c_f32_bf16 v4, v92, v18
    v_dot2c_f32_bf16 v2, v85, v11
    v_dot2c_f32_bf16 v3, v89, v15
    v_dot2c_f32_bf16 v4, v93, v19
    v_dot2c_f32_bf16 v2, v86, v12
    v_dot2c_f32_bf16 v3, v90, v16
    v_dot2c_f32_bf16 v4, v94, v20
    v_dot2c_f32_bf16 v2, v87, v13
    v_dot2c_f32_bf16 v3, v91, v17
    v_dot2c_f32_bf16 v4, v95, v21
    s_nop 1
    v_add_f32 v2, v2, v3
    v_add_f32 v2, v2, v4
    s_nop 1
    v_add_f32_dpp v2, v2, v2 quad_perm:[1,0,3,2] row_mask:0xf bank_mask:0xf
    s_nop 1
    v_add_f32_dpp v2, v2, v2 quad_perm:[2,3,0,1] row_mask:0xf bank_mask:0xf
    s_nop 1
    v_add_f32_dpp v2, v2, v2 row_half_mirror row_mask:0xf bank_mask:0xf
    v_cvt_pk_bf16_f32 v2, v2, v2
    v_and_b32 v2, s7, v2
    v_mul_f32 v2, s43, v2
    v_cvt_pk_bf16_f32 v2, v2, v2
    v_and_b32 v2, s7, v2
    v_min_u32 v2, -2, v2
    ds_write_b32 v9, v2 offset:1152
    s_waitcnt vmcnt(9)
    v_mov_b32 v2, 0
    v_mov_b32 v3, 0
    v_mov_b32 v4, 0
    v_dot2c_f32_bf16 v2, v96, v10
    v_dot2c_f32_bf16 v3, v100, v14
    v_dot2c_f32_bf16 v4, v104, v18
    v_dot2c_f32_bf16 v2, v97, v11
    v_dot2c_f32_bf16 v3, v101, v15
    v_dot2c_f32_bf16 v4, v105, v19
    v_dot2c_f32_bf16 v2, v98, v12
    v_dot2c_f32_bf16 v3, v102, v16
    v_dot2c_f32_bf16 v4, v106, v20
    v_dot2c_f32_bf16 v2, v99, v13
    v_dot2c_f32_bf16 v3, v103, v17
    v_dot2c_f32_bf16 v4, v107, v21
    s_nop 1
    v_add_f32 v2, v2, v3
    v_add_f32 v2, v2, v4
    s_nop 1
    v_add_f32_dpp v2, v2, v2 quad_perm:[1,0,3,2] row_mask:0xf bank_mask:0xf
    s_nop 1
    v_add_f32_dpp v2, v2, v2 quad_perm:[2,3,0,1] row_mask:0xf bank_mask:0xf
    s_nop 1
    v_add_f32_dpp v2, v2, v2 row_half_mirror row_mask:0xf bank_mask:0xf
    v_cvt_pk_bf16_f32 v2, v2, v2
    v_and_b32 v2, s7, v2
    v_mul_f32 v2, s43, v2
    v_cvt_pk_bf16_f32 v2, v2, v2
    v_and_b32 v2, s7, v2
    v_min_u32 v2, -2, v2
    ds_write_b32 v9, v2 offset:1536
    s_waitcnt vmcnt(6)
    v_mov_b32 v2, 0
    v_mov_b32 v3, 0
    v_mov_b32 v4, 0
    v_dot2c_f32_bf16 v2, v108, v10
    v_dot2c_f32_bf16 v3, v112, v14
    v_dot2c_f32_bf16 v4, v116, v18
    v_dot2c_f32_bf16 v2, v109, v11
    v_dot2c_f32_bf16 v3, v113, v15
    v_dot2c_f32_bf16 v4, v117, v19
    v_dot2c_f32_bf16 v2, v110, v12
    v_dot2c_f32_bf16 v3, v114, v16
    v_dot2c_f32_bf16 v4, v118, v20
    v_dot2c_f32_bf16 v2, v111, v13
    v_dot2c_f32_bf16 v3, v115, v17
    v_dot2c_f32_bf16 v4, v119, v21
    s_nop 1
    v_add_f32 v2, v2, v3
    v_add_f32 v2, v2, v4
    s_nop 1
    v_add_f32_dpp v2, v2, v2 quad_perm:[1,0,3,2] row_mask:0xf bank_mask:0xf
    s_nop 1
    v_add_f32_dpp v2, v2, v2 quad_perm:[2,3,0,1] row_mask:0xf bank_mask:0xf
    s_nop 1
    v_add_f32_dpp v2, v2, v2 row_half_mirror row_mask:0xf bank_mask:0xf
    v_cvt_pk_bf16_f32 v2, v2, v2
    v_and_b32 v2, s7, v2
    v_mul_f32 v2, s43, v2
    v_cvt_pk_bf16_f32 v2, v2, v2
    v_and_b32 v2, s7, v2
    v_min_u32 v2, -2, v2
    ds_write_b32 v9, v2 offset:1920
    s_waitcnt vmcnt(0)
    v_lshl_add_u32 v120, v0, 4, s11
    ds_read_b128 v[72:75], v120 offset:16384
    ds_read_b128 v[76:79], v120 offset:17408
    ds_read_b128 v[80:83], v120 offset:18432
    ds_read_b128 v[84:87], v120 offset:19456
    ds_read_b128 v[88:91], v120 offset:20480
    ds_read_b128 v[92:95], v120 offset:21504
    s_waitcnt lgkmcnt(3)
    v_mov_b32 v2, 0
    v_mov_b32 v3, 0
    v_mov_b32 v4, 0
    v_dot2c_f32_bf16 v2, v72, v10
    v_dot2c_f32_bf16 v3, v76, v14
    v_dot2c_f32_bf16 v4, v80, v18
    v_dot2c_f32_bf16 v2, v73, v11
    v_dot2c_f32_bf16 v3, v77, v15
    v_dot2c_f32_bf16 v4, v81, v19
    v_dot2c_f32_bf16 v2, v74, v12
    v_dot2c_f32_bf16 v3, v78, v16
    v_dot2c_f32_bf16 v4, v82, v20
    v_dot2c_f32_bf16 v2, v75, v13
    v_dot2c_f32_bf16 v3, v79, v17
    v_dot2c_f32_bf16 v4, v83, v21
    s_nop 1
    v_add_f32 v2, v2, v3
    v_add_f32 v2, v2, v4
    s_nop 1
    v_add_f32_dpp v2, v2, v2 quad_perm:[1,0,3,2] row_mask:0xf bank_mask:0xf
    s_nop 1
    v_add_f32_dpp v2, v2, v2 quad_perm:[2,3,0,1] row_mask:0xf bank_mask:0xf
    s_nop 1
    v_add_f32_dpp v2, v2, v2 row_half_mirror row_mask:0xf bank_mask:0xf
    v_cvt_pk_bf16_f32 v2, v2, v2
    v_and_b32 v2, s7, v2
    v_mul_f32 v2, s43, v2
    v_cvt_pk_bf16_f32 v2, v2, v2
    v_and_b32 v2, s7, v2
    v_min_u32 v2, -2, v2
    ds_write_b32 v9, v2 offset:2304
    s_waitcnt lgkmcnt(0)
    v_mov_b32 v2, 0
    v_mov_b32 v3, 0
    v_mov_b32 v4, 0
    v_dot2c_f32_bf16 v2, v84, v10
    v_dot2c_f32_bf16 v3, v88, v14
    v_dot2c_f32_bf16 v4, v92, v18
    v_dot2c_f32_bf16 v2, v85, v11
    v_dot2c_f32_bf16 v3, v89, v15
    v_dot2c_f32_bf16 v4, v93, v19
    v_dot2c_f32_bf16 v2, v86, v12
    v_dot2c_f32_bf16 v3, v90, v16
    v_dot2c_f32_bf16 v4, v94, v20
    v_dot2c_f32_bf16 v2, v87, v13
    v_dot2c_f32_bf16 v3, v91, v17
    v_dot2c_f32_bf16 v4, v95, v21
    s_nop 1
    v_add_f32 v2, v2, v3
    v_add_f32 v2, v2, v4
    s_nop 1
    v_add_f32_dpp v2, v2, v2 quad_perm:[1,0,3,2] row_mask:0xf bank_mask:0xf
    s_nop 1
    v_add_f32_dpp v2, v2, v2 quad_perm:[2,3,0,1] row_mask:0xf bank_mask:0xf
    s_nop 1
    v_add_f32_dpp v2, v2, v2 row_half_mirror row_mask:0xf bank_mask:0xf
    v_cvt_pk_bf16_f32 v2, v2, v2
    v_and_b32 v2, s7, v2
    v_mul_f32 v2, s43, v2
    v_cvt_pk_bf16_f32 v2, v2, v2
    v_and_b32 v2, s7, v2
    v_min_u32 v2, -2, v2
    ds_write_b32 v9, v2 offset:2688
L_retired:
    v_mov_b32 v52, 0
    v_mov_b32 v53, 1
    s_cmp_eq_u32 s3, 15
    s_cbranch_scc1 L_fwave
    s_sub_u32 s9, s3, 12
    s_lshl_b32 s8, s9, 8
    v_lshl_add_u32 v4, v0, 2, s8
    v_and_b32 v11, 7, v0
    v_lshlrev_b32 v11, 3, v11
    v_add_u32 v12, 6912, v4
    s_lshl_b32 s8, s4, 3
    s_add_u32 s8, s8, s5
    s_lshl_b32 s8, s8, 10
    s_add_u32 s8, s8, 1048576
    v_add_u32 v4, s8, v4
LW_11:
    ds_read_b32 v5, v52 offset:516
    s_waitcnt lgkmcnt(0)
    v_readfirstlane_b32 s8, v5
    s_nop 0
    s_cmp_ge_u32 s8, 1
    s_cbranch_scc1 L_cnear
    s_add_u32 s67, s67, 1
    s_cmp_gt_u32 s67, 16000000
    s_cbranch_scc1 L_end
    s_sleep 4
    s_branch LW_11
L_cnear:
LW_12:
    ds_read_b32 v5, v52 offset:516
    s_waitcnt lgkmcnt(0)
    v_readfirstlane_b32 s8, v5
    s_nop 0
    s_cmp_ge_u32 s8, 8
    s_cbranch_scc1 L_cml
    s_add_u32 s67, s67, 1
    s_cmp_gt_u32 s67, 16000000
    s_cbranch_scc1 L_end
    s_branch LW_12
L_cml:
    ds_read_b64 v[6:7], v11 offset:576
    s_waitcnt lgkmcnt(0)
    v_mov_b32 v8, v6
    s_nop 1
    v_max_f32_dpp v8, v8, v8 quad_perm:[1,0,3,2] row_mask:0xf bank_mask:0xf
    s_nop 1
    v_max_f32_dpp v8, v8, v8 quad_perm:[2,3,0,1] row_mask:0xf bank_mask:0xf
    s_nop 1
    v_max_f32_dpp v8, v8, v8 row_half_mirror row_mask:0xf bank_mask:0xf
    v_sub_f32 v6, v6, v8
    v_mul_f32 v6, s42, v6
    v_exp_f32 v6, v6
    v_mov_b32 v40, 0
    v_mov_b32 v41, 0
    v_mul_f32 v9, v7, v6
    s_setprio 3
    s_cmp_lg_u32 s9, 0
    s_cbranch_scc1 L_cwait
    v_add_f32_dpp v9, v9, v9 quad_perm:[1,0,3,2] row_mask:0xf bank_mask:0xf
    s_nop 1
    v_add_f32_dpp v9, v9, v9 quad_perm:[2,3,0,1] row_mask:0xf bank_mask:0xf
    s_nop 1
    v_add_f32_dpp v9, v9, v9 row_half_mirror row_mask:0xf bank_mask:0xf
    v_min_u32 v8, -2, v8
    v_min_u32 v9, -2, v9
    s_mov_b64 exec, 1
    global_store_dwordx2 v4, v[8:9], s[40:41] offset:768 sc1
    s_mov_b64 exec, -1
L_cwait:
LW_13:
    ds_read_b32 v5, v52 offset:520
    s_waitcnt lgkmcnt(0)
    v_readfirstlane_b32 s8, v5
    s_nop 0
    s_cmp_ge_u32 s8, 8
    s_cbranch_scc1 L_cgo
    s_add_u32 s67, s67, 1
    s_cmp_gt_u32 s67, 16000000
    s_cbranch_scc1 L_end
    s_branch LW_13
L_cgo:
    ds_read2st64_b32 v[24:25], v12 offset0:0 offset1:3
    ds_read2st64_b32 v[26:27], v12 offset0:6 offset1:9
    ds_read2st64_b32 v[28:29], v12 offset0:12 offset1:15
    ds_read2st64_b32 v[30:31], v12 offset0:18 offset1:21
    s_waitcnt lgkmcnt(3)
    v_fmac_f32_dpp v40, v6, v24 row_newbcast:0 row_mask:0xf bank_mask:0xf
    v_fmac_f32_dpp v41, v6, v25 row_newbcast:1 row_mask:0xf bank_mask:0xf
    s_waitcnt lgkmcnt(2)
    v_fmac_f32_dpp v40, v6, v26 row_newbcast:2 row_mask:0xf bank_mask:0xf
    v_fmac_f32_dpp v41, v6, v27 row_newbcast:3 row_mask:0xf bank_mask:0xf
    s_waitcnt lgkmcnt(1)
    v_fmac_f32_dpp v40, v6, v28 row_newbcast:4 row_mask:0xf bank_mask:0xf
    v_fmac_f32_dpp v41, v6, v29 row_newbcast:5 row_mask:0xf bank_mask:0xf
    s_waitcnt lgkmcnt(0)
    v_fmac_f32_dpp v40, v6, v30 row_newbcast:6 row_mask:0xf bank_mask:0xf
    v_fmac_f32_dpp v41, v6, v31 row_newbcast:7 row_mask:0xf bank_mask:0xf
    v_add_f32 v40, v40, v41
    v_min_u32 v40, -2, v40
    global_store_dword v4, v40, s[40:41] sc1
    s_mov_b64 exec, 1
    ds_add_u32 v52, v53 offset:520
    s_mov_b64 exec, -1
    s_branch L_end
L_tail:
    s_setprio 0
    v_lshrrev_b32 v2, 4, v0
    v_and_b32 v3, 15, v0
    v_lshrrev_b32 v10, 2, v3
    v_lshl_add_u32 v10, v2, 3, v10
    v_and_b32 v11, 3, v0
    v_mov_b32 v4, 0
    v_lshrrev_b32 v12, 2, v0
    v_and_b32 v13, 31, v0
    v_lshlrev_b32 v13, 2, v13
    s_mov_b32 s14, 0xffff0000
    s_mov_b32 s15, 0xffff0000
    s_mov_b32 s55, 0x20000
    s_mov_b32 s59, 0x20000
LW_14:
    ds_read_b32 v5, v4 offset:516
    s_waitcnt lgkmcnt(0)
    v_readfirstlane_b32 s8, v5
    s_nop 0
    s_cmp_ge_u32 s8, 1
    s_cbranch_scc1 L_near
    s_add_u32 s67, s67, 1
    s_cmp_gt_u32 s67, 16000000
    s_cbranch_scc1 L_end
    s_sleep 4
    s_branch LW_14
L_near:
    s_cmp_lg_u32 s3, 0
    s_cbranch_scc1 L_rolewait
    s_and_b32 s9, s2, 7
    s_mul_i32 s8, s9, 1152
    s_add_u32 s8, s8, 40960
    s_add_u32 s60, s40, s8
    s_addc_u32 s61, s41, 0
LW_15:
    ds_read_b32 v5, v4 offset:516
    s_waitcnt lgkmcnt(0)
    v_readfirstlane_b32 s8, v5
    s_nop 0
    s_cmp_ge_u32 s8, 8
    s_cbranch_scc1 L_roleget
    s_add_u32 s67, s67, 1
    s_cmp_gt_u32 s67, 16000000
    s_cbranch_scc1 L_end
    s_branch LW_15
L_roleget:
    s_mov_b32 s8, 1
    s_atomic_add s8, s[60:61], 0 glc
    s_waitcnt lgkmcnt(0)
    s_lshl_b32 s8, s8, 3
    s_add_u32 s8, s8, s9
    s_add_u32 s8, s8, 1
    v_mov_b32 v5, s8
    ds_write_b32 v4, v5 offset:524
    s_branch L_rolegot
L_rolewait:
LW_16:
    ds_read_b32 v5, v4 offset:524
    s_waitcnt lgkmcnt(0)
    v_readfirstlane_b32 s8, v5
    s_nop 0
    s_cmp_ge_u32 s8, 1
    s_cbranch_scc1 L_rolegot
    s_add_u32 s67, s67, 1
    s_cmp_gt_u32 s67, 16000000
    s_cbranch_scc1 L_end
    s_branch LW_16
L_rolegot:
    s_sub_u32 s66, s8, 1
    s_cmp_lt_u32 s66, 48
    s_cbranch_scc1 L_notw
    s_sub_u32 s64, s66, 48
    s_cmp_ge_u32 s64, 160
    s_cbranch_scc1 L_end
    s_mul_i32 s65, s64, 205
    s_lshr_b32 s65, s65, 11
    s_mul_i32 s8, s65, 10
    s_sub_u32 s64, s64, s8
    s_lshl_b32 s9, s65, 2
    s_add_u32 s9, s9, s3
    s_mul_i32 s8, s9, 122880
    s_lshl_b32 s10, s64, 7
    s_add_u32 s8, s8, s10
    s_add_u32 s52, s24, s8
    s_addc_u32 s53, s25, 0
    s_sub_u32 s54, 7864320, s8
    v_lshrrev_b32 v14, 3, v0
    v_mul_u32_u24 v14, 1280, v14
    v_and_b32 v16, 7, v0
    v_lshl_add_u32 v14, v16, 4, v14
    s_mul_i32 s11, s3, 12288
    s_mov_b32 s10, 0
    s_add_u32 m0, s11, 16384
    s_nop 0
    buffer_load_dwordx4 v14, s[52:55], s10 offen  lds
    s_mov_b32 s10, 10240
    s_add_u32 m0, s11, 17408
    s_nop 0
    buffer_load_dwordx4 v14, s[52:55], s10 offen  lds
    s_mov_b32 s10, 20480
    s_add_u32 m0, s11, 18432
    s_nop 0
    buffer_load_dwordx4 v14, s[52:55], s10 offen  lds
    s_mov_b32 s10, 30720
    s_add_u32 m0, s11, 19456
    s_nop 0
    buffer_load_dwordx4 v14, s[52:55], s10 offen  lds
    s_mov_b32 s10, 40960
    s_add_u32 m0, s11, 20480
    s_nop 0
    buffer_load_dwordx4 v14, s[52:55], s10 offen  lds
    s_mov_b32 s10, 51200
    s_add_u32 m0, s11, 21504
    s_nop 0
    buffer_load_dwordx4 v14, s[52:55], s10 offen  lds
    s_mov_b32 s10, 61440
    s_add_u32 m0, s11, 22528
    s_nop 0
    buffer_load_dwordx4 v14, s[52:55], s10 offen  lds
    s_mov_b32 s10, 71680
    s_add_u32 m0, s11, 23552
    s_nop 0
    buffer_load_dwordx4 v14, s[52:55], s10 offen  lds
    s_mov_b32 s10, 81920
    s_add_u32 m0, s11, 24576
    s_nop 0
    buffer_load_dwordx4 v14, s[52:55], s10 offen  lds
    s_mov_b32 s10, 92160
    s_add_u32 m0, s11, 25600
    s_nop 0
    buffer_load_dwordx4 v14, s[52:55], s10 offen  lds
    s_mov_b32 s10, 102400
    s_add_u32 m0, s11, 26624
    s_nop 0
    buffer_load_dwordx4 v14, s[52:55], s10 offen  lds
    s_mov_b32 s10, 112640
    s_add_u32 m0, s11, 27648
    s_nop 0
    buffer_load_dwordx4 v14, s[52:55], s10 offen  lds
    v_lshlrev_b32 v15, 7, v10
    v_lshl_add_u32 v15, v11, 3, v15
    v_add_u32 v15, s11, v15
    s_lshr_b32 s9, s9, 1
    s_lshl_b32 s9, s9, 13
    s_add_u32 s9, s9, 1048576
    v_lshl_add_u32 v16, v16, 10, s9
    s_and_b32 s8, s3, 1
    s_mul_i32 s8, s8, 384
    s_add_u32 s9, s9, s8
    v_lshlrev_b32 v17, 11, v2
    v_lshl_add_u32 v17, v3, 3, v17
    v_add_u32 v17, s9, v17
    s_mul_i32 s8, s3, 384
    v_and_b32 v19, 1, v2
    v_lshl_add_u32 v18, v3, 1, v19
    v_lshl_add_u32 v18, v18, 1, s8
    v_lshrrev_b32 v19, 5, v0
    v_lshl_add_u32 v12, v19, 7, v18
    v_lshl_add_u32 v19, v2, 4, s8
    v_lshlrev_b32 v13, 2, v0
    s_lshl_b32 s8, s3, 8
    v_add_u32 v20, s8, v13
    s_mul_i32 s8, s65, 2560
    s_lshl_b32 s10, s64, 8
    s_add_u32 s8, s8, s10
    s_add_u32 s8, s8, 1433600
    v_add_u32 v21, s8, v13
    s_mov_b32 s12, 0
    s_mov_b32 s13, -1
    s_setprio 2
ML_17:
    global_load_dwordx2 v[6:7], v16, s[40:41] offset:768 sc1
    global_load_dwordx2 v[112:113], v17, s[40:41] offset:0 sc1
    global_load_dwordx2 v[114:115], v17, s[40:41] offset:1024 sc1
    global_load_dwordx2 v[116:117], v17, s[40:41] offset:128 sc1
    global_load_dwordx2 v[118:119], v17, s[40:41] offset:1152 sc1
    global_load_dwordx2 v[120:121], v17, s[40:41] offset:256 sc1
    global_load_dwordx2 v[122:123], v17, s[40:41] offset:1280 sc1
    s_waitcnt vmcnt(0)
    v_max_u32 v8, v6, v7
    v_cmp_eq_u32 vcc, -1, v8
    s_cbranch_vccz GD_18
    s_add_u32 s67, s67, 1
    s_cmp_gt_u32 s67, 2000000
    s_cbranch_scc1 L_end
    s_sleep 1
    s_branch ML_17
GD_18:
    ds_read_b64_tr_b16 v[64:65], v15 offset:16384
    ds_read_b64_tr_b16 v[66:67], v15 offset:16896
    ds_read_b64_tr_b16 v[68:69], v15 offset:16416
    ds_read_b64_tr_b16 v[70:71], v15 offset:16928
    ds_read_b64_tr_b16 v[72:73], v15 offset:16448
    ds_read_b64_tr_b16 v[74:75], v15 offset:16960
    ds_read_b64_tr_b16 v[76:77], v15 offset:16480
    ds_read_b64_tr_b16 v[78:79], v15 offset:16992
    ds_read_b64_tr_b16 v[80:81], v15 offset:20480
    ds_read_b64_tr_b16 v[82:83], v15 offset:20992
    ds_read_b64_tr_b16 v[84:85], v15 offset:20512
    ds_read_b64_tr_b16 v[86:87], v15 offset:21024
    ds_read_b64_tr_b16 v[88:89], v15 offset:20544
    ds_read_b64_tr_b16 v[90:91], v15 offset:21056
    ds_read_b64_tr_b16 v[92:93], v15 offset:20576
    ds_read_b64_tr_b16 v[94:95], v15 offset:21088
    ds_read_b64_tr_b16 v[96:97], v15 offset:24576
    ds_read_b64_tr_b16 v[98:99], v15 offset:25088
    ds_read_b64_tr_b16 v[100:101], v15 offset:24608
    ds_read_b64_tr_b16 v[102:103], v15 offset:25120
    ds_read_b64_tr_b16 v[104:105], v15 offset:24640
    ds_read_b64_tr_b16 v[106:107], v15 offset:25152
    ds_read_b64_tr_b16 v[108:109], v15 offset:24672
    ds_read_b64_tr_b16 v[110:111], v15 offset:25184
    v_mov_b32 v8, v6
    s_nop 1
    v_max_f32_dpp v8, v8, v8 quad_perm:[1,0,3,2] row_mask:0xf bank_mask:0xf
    s_nop 1
    v_max_f32_dpp v8, v8, v8 quad_perm:[2,3,0,1] row_mask:0xf bank_mask:0xf
    s_nop 1
    v_max_f32_dpp v8, v8, v8 row_half_mirror row_mask:0xf bank_mask:0xf
    v_sub_f32 v6, v6, v8
    v_mul_f32 v6, s42, v6
    v_exp_f32 v6, v6
    s_nop 0
    v_mul_f32 v7, v7, v6
    s_nop 1
    v_add_f32_dpp v7, v7, v7 quad_perm:[1,0,3,2] row_mask:0xf bank_mask:0xf
    s_nop 1
    v_add_f32_dpp v7, v7, v7 quad_perm:[2,3,0,1] row_mask:0xf bank_mask:0xf
    s_nop 1
    v_add_f32_dpp v7, v7, v7 row_half_mirror row_mask:0xf bank_mask:0xf
    v_rcp_f32 v7, v7
    s_nop 0
    v_mul_f32 v6, v6, v7
    s_nop 1
    v_mov_b32_dpp v8, v6 row_newbcast:0 row_mask:0x1 bank_mask:0xf
    v_mov_b32_dpp v22, v6 row_newbcast:1 row_mask:0x1 bank_mask:0xf
    s_nop 0
    v_mov_b32_dpp v8, v6 row_newbcast:2 row_mask:0x2 bank_mask:0xf
    v_mov_b32_dpp v22, v6 row_newbcast:3 row_mask:0x2 bank_mask:0xf
    s_nop 0
    v_mov_b32_dpp v8, v6 row_newbcast:4 row_mask:0x4 bank_mask:0xf
    v_mov_b32_dpp v22, v6 row_newbcast:5 row_mask:0x4 bank_mask:0xf
    s_nop 0
    v_mov_b32_dpp v8, v6 row_newbcast:6 row_mask:0x8 bank_mask:0xf
    v_mov_b32_dpp v22, v6 row_newbcast:7 row_mask:0x8 bank_mask:0xf
    s_mov_b32 s70, 0
    s_waitcnt lgkmcnt(0)
    s_branch L_g3chk
G3_19:
    s_cmp_lg_u32 s70, 0
    s_cbranch_scc1 L_g3ld
    s_mov_b32 s70, 1
LW_20:
    ds_read_b32 v5, v4 offset:520
    s_waitcnt lgkmcnt(0)
    v_readfirstlane_b32 s8, v5
    s_nop 0
    s_cmp_ge_u32 s8, 11
    s_cbranch_scc1 L_g3ld
    s_add_u32 s67, s67, 1
    s_cmp_gt_u32 s67, 16000000
    s_cbranch_scc1 L_end
    s_sleep 1
    s_branch LW_20
L_g3ld:
    s_mov_b64 exec, s[68:69]
    global_load_dwordx2 v[112:113], v17, s[40:41] offset:0 sc1
    global_load_dwordx2 v[114:115], v17, s[40:41] offset:1024 sc1
    global_load_dwordx2 v[116:117], v17, s[40:41] offset:128 sc1
    global_load_dwordx2 v[118:119], v17, s[40:41] offset:1152 sc1
    global_load_dwordx2 v[120:121], v17, s[40:41] offset:256 sc1
    global_load_dwordx2 v[122:123], v17, s[40:41] offset:1280 sc1
    s_mov_b64 exec, -1
L_g3chk:
    s_waitcnt vmcnt(0)
    v_pk_mul_f32 v[48:49], v[112:113], v[8:9] op_sel_hi:[1,0]
    v_pk_mul_f32 v[50:51], v[116:117], v[8:9] op_sel_hi:[1,0]
    v_pk_mul_f32 v[52:53], v[120:121], v[8:9] op_sel_hi:[1,0]
    v_pk_fma_f32 v[48:49], v[114:115], v[22:23], v[48:49] op_sel_hi:[1,0,1]
    v_pk_fma_f32 v[50:51], v[118:119], v[22:23], v[50:51] op_sel_hi:[1,0,1]
    v_pk_fma_f32 v[52:53], v[122:123], v[22:23], v[52:53] op_sel_hi:[1,0,1]
    v_pk_add_f32 v[56:57], v[48:49], v[50:51]
    v_pk_add_f32 v[56:57], v[56:57], v[52:53]
    v_cmp_u_f32 vcc, v56, v57
    s_cbranch_vccz NR_21
    s_mov_b64 s[68:69], vcc
    s_add_u32 s67, s67, 1
    s_and_b32 s8, s67, 15
    s_cbranch_scc1 G3_19
    s_cmp_gt_u32 s67, 2000000
    s_cbranch_scc1 L_end
    s_cmp_eq_u32 s63, 1
    s_cbranch_scc1 NR_21
    v_mov_b32 v60, v112
    v_max3_u32 v60, v60, v113, v114
    v_max3_u32 v60, v60, v115, v116
    v_max3_u32 v60, v60, v117, v118
    v_max3_u32 v60, v60, v119, v120
    v_max3_u32 v60, v60, v121, v122
    v_max_u32 v60, v60, v123
    v_cmp_eq_u32 vcc, -1, v60
    s_cbranch_vccnz G3_19
    s_mov_b32 s63, 1
    s_branch G3_19
NR_21:
    v_mov_b32 v54, v50
    v_mov_b32 v55, v51
    v_permlane32_swap_b32 v48, v52
    v_permlane32_swap_b32 v49, v53
    v_permlane32_swap_b32 v50, v54
    v_permlane32_swap_b32 v51, v55
    v_pk_add_f32 v[48:49], v[48:49], v[52:53]
    v_pk_add_f32 v[50:51], v[50:51], v[54:55]
    s_nop 0
    v_permlane16_swap_b32 v48, v49
    v_permlane16_swap_b32 v50, v51
    v_add_f32 v48, v48, v49
    v_add_f32 v50, v50, v51
    v_cvt_pk_bf16_f32 v48, v48, v48
    v_cvt_pk_bf16_f32 v50, v50, v50
    ds_write_b16 v12, v48 offset:1024
    ds_write_b16 v18, v50 offset:1088
    ds_read_b128 v[24:27], v19 offset:1024
    ds_read_b128 v[28:31], v19 offset:1088
    ds_read_b128 v[32:35], v19 offset:1152
    s_waitcnt lgkmcnt(2)
    v_mfma_f32_16x16x32_bf16 v[40:43], v[24:27], v[64:67], 0
    v_mfma_f32_16x16x32_bf16 v[44:47], v[24:27], v[68:71], 0
    v_mfma_f32_16x16x32_bf16 v[48:51], v[24:27], v[72:75], 0
    v_mfma_f32_16x16x32_bf16 v[52:55], v[24:27], v[76:79], 0
    s_waitcnt lgkmcnt(1)
    v_mfma_f32_16x16x32_bf16 v[40:43], v[28:31], v[80:83], v[40:43]
    v_mfma_f32_16x16x32_bf16 v[44:47], v[28:31], v[84:87], v[44:47]
    v_mfma_f32_16x16x32_bf16 v[48:51], v[28:31], v[88:91], v[48:51]
    v_mfma_f32_16x16x32_bf16 v[52:55], v[28:31], v[92:95], v[52:55]
    s_waitcnt lgkmcnt(0)
    v_mfma_f32_16x16x32_bf16 v[40:43], v[32:35], v[96:99], v[40:43]
    v_mfma_f32_16x16x32_bf16 v[44:47], v[32:35], v[100:103], v[44:47]
    v_mfma_f32_16x16x32_bf16 v[48:51], v[32:35], v[104:107], v[48:51]
    v_mfma_f32_16x16x32_bf16 v[52:55], v[32:35], v[108:111], v[52:55]
    s_nop 5
    v_cndmask_b32 v56, v40, v44, s[14:15]
    s_nop 0
    v_cndmask_b32 v57, v48, v52, s[14:15]
    v_cndmask_b32 v56, v56, v57, s[12:13]
    ds_write_b32 v20, v56 offset:3072
    s_waitcnt lgkmcnt(0)
    s_barrier
    s_cmp_lg_u32 s3, 0
    s_cbranch_scc1 L_end
    ds_read2st64_b32 v[24:25], v13 offset0:12 offset1:13
    ds_read2st64_b32 v[26:27], v13 offset0:14 offset1:15
    s_waitcnt lgkmcnt(1)
    v_add_f32 v24, v24, v25
    s_waitcnt lgkmcnt(0)
    v_add_f32 v26, v26, v27
    v_add_f32 v24, v24, v26
    v_min_u32 v24, -2, v24
    global_store_dword v21, v24, s[40:41] sc1
    s_branch L_end
L_notw:
    s_mul_i32 s9, s3, 320
    v_and_b32 v5, 1, v2
    v_lshl_add_u32 v5, v3, 1, v5
    v_lshrrev_b32 v6, 5, v0
    v_lshl_add_u32 v6, v6, 6, v5
    v_add_u32 v7, 128, v5
    s_mul_i32 s8, s3, 160
    v_lshl_add_u32 v17, v6, 1, s9
    v_lshl_add_u32 v18, v7, 1, s9
    v_add_u32 v6, s8, v6
    v_add_u32 v7, s8, v7
    v_lshlrev_b32 v19, 2, v6
    v_lshlrev_b32 v20, 2, v7
    v_lshlrev_b32 v8, 2, v0
    global_load_ushort v40, v17, s[16:17]
    global_load_ushort v41, v17, s[16:17] offset:64
    global_load_ushort v42, v18, s[16:17]
    global_load_dword v24, v8, s[16:17] offset:0
    global_load_dword v25, v8, s[16:17] offset:256
    global_load_dword v26, v8, s[16:17] offset:512
    global_load_dword v27, v8, s[16:17] offset:768
    global_load_dword v28, v8, s[16:17] offset:1024
    v_lshlrev_b32 v32, 3, v6
    v_lshlrev_b32 v33, 3, v7
    v_add_u32 v32, 75776, v32
    v_add_u32 v33, 75776, v33
    v_add_u32 v8, 5120, v32
    v_add_u32 v9, 5120, v33
    v_add_u32 v21, 10240, v32
    v_add_u32 v22, 10240, v33
    global_load_dwordx2 v[88:89], v32, s[40:41] offset:0 sc1
    global_load_dwordx2 v[90:91], v32, s[40:41] offset:256 sc1
    global_load_dwordx2 v[92:93], v33, s[40:41] offset:0 sc1
    global_load_dwordx2 v[94:95], v8, s[40:41] offset:0 sc1
    global_load_dwordx2 v[96:97], v8, s[40:41] offset:256 sc1
    global_load_dwordx2 v[98:99], v9, s[40:41] offset:0 sc1
    global_load_dwordx2 v[100:101], v21, s[40:41] offset:0 sc1
    global_load_dwordx2 v[102:103], v21, s[40:41] offset:256 sc1
    global_load_dwordx2 v[104:105], v22, s[40:41] offset:0 sc1
    s_mul_i32 s8, s3, 491520
    s_lshl_b32 s10, s66, 6
    s_add_u32 s8, s8, s10
    s_add_u32 s52, s28, s8
    s_addc_u32 s53, s29, 0
    s_sub_u32 s54, 1966080, s8
    s_mul_i32 s11, s3, 10240
    s_mul_i32 s8, s66, 40960
    s_add_u32 s8, s8, s11
    s_add_u32 s56, s30, s8
    s_addc_u32 s57, s31, 0
    s_mov_b32 s58, 10240
    s_mul_i32 s72, s3, 10496
    v_mov_b32 v31, 0x10000
    v_mul_u32_u24 v14, 3072, v12
    v_lshl_add_u32 v14, v11, 4, v14
    s_mov_b32 s10, 0
    s_add_u32 m0, s11, 16384
    s_nop 0
    buffer_load_dwordx4 v14, s[52:55], s10 offen  lds
    s_mov_b32 s10, 49152
    s_add_u32 m0, s11, 17408
    s_nop 0
    buffer_load_dwordx4 v14, s[52:55], s10 offen  lds
    s_mov_b32 s10, 98304
    s_add_u32 m0, s11, 18432
    s_nop 0
    buffer_load_dwordx4 v14, s[52:55], s10 offen  lds
    s_mov_b32 s10, 147456
    s_add_u32 m0, s11, 19456
    s_nop 0
    buffer_load_dwordx4 v14, s[52:55], s10 offen  lds
    s_mov_b32 s10, 196608
    s_add_u32 m0, s11, 20480
    s_nop 0
    buffer_load_dwordx4 v14, s[52:55], s10 offen  lds
    s_mov_b32 s10, 245760
    s_add_u32 m0, s11, 21504
    s_nop 0
    buffer_load_dwordx4 v14, s[52:55], s10 offen  lds
    s_mov_b32 s10, 294912
    s_add_u32 m0, s11, 22528
    s_nop 0
    buffer_load_dwordx4 v14, s[52:55], s10 offen  lds
    s_mov_b32 s10, 344064
    s_add_u32 m0, s11, 23552
    s_nop 0
    buffer_load_dwordx4 v14, s[52:55], s10 offen  lds
    s_mov_b32 s10, 393216
    s_add_u32 m0, s11, 24576
    s_nop 0
    buffer_load_dwordx4 v14, s[52:55], s10 offen  lds
    s_mov_b32 s10, 442368
    s_add_u32 m0, s11, 25600
    s_nop 0
    buffer_load_dwordx4 v14, s[52:55], s10 offen  lds
    v_add_u32 v5, 0, v0
    v_mul_u32_u24 v6, 800, v5
    v_lshrrev_b32 v6, 16, v6
    v_mul_u32_u24 v7, 82, v6
    v_sub_u32 v7, v5, v7
    v_lshlrev_b32 v6, 5, v6
    v_lshlrev_b32 v5, 4, v5
    v_sub_u32 v5, v5, v6
    v_cmp_lt_u32 vcc, 79, v7
    s_nop 1
    v_cndmask_b32 v30, v5, v31, vcc
    s_add_u32 m0, s72, 90112
    s_nop 0
    buffer_load_dwordx4 v30, s[56:59], 0 offen  lds
    v_add_u32 v5, 64, v0
    v_mul_u32_u24 v6, 800, v5
    v_lshrrev_b32 v6, 16, v6
    v_mul_u32_u24 v7, 82, v6
    v_sub_u32 v7, v5, v7
    v_lshlrev_b32 v6, 5, v6
    v_lshlrev_b32 v5, 4, v5
    v_sub_u32 v5, v5, v6
    v_cmp_lt_u32 vcc, 79, v7
    s_nop 1
    v_cndmask_b32 v30, v5, v31, vcc
    s_add_u32 m0, s72, 91136
    s_nop 0
    buffer_load_dwordx4 v30, s[56:59], 0 offen  lds
    v_add_u32 v5, 128, v0
    v_mul_u32_u24 v6, 800, v5
    v_lshrrev_b32 v6, 16, v6
    v_mul_u32_u24 v7, 82, v6
    v_sub_u32 v7, v5, v7
    v_lshlrev_b32 v6, 5, v6
    v_lshlrev_b32 v5, 4, v5
    v_sub_u32 v5, v5, v6
    v_cmp_lt_u32 vcc, 79, v7
    s_nop 1
    v_cndmask_b32 v30, v5, v31, vcc
    s_add_u32 m0, s72, 92160
    s_nop 0
    buffer_load_dwordx4 v30, s[56:59], 0 offen  lds
    v_add_u32 v5, 192, v0
    v_mul_u32_u24 v6, 800, v5
    v_lshrrev_b32 v6, 16, v6
    v_mul_u32_u24 v7, 82, v6
    v_sub_u32 v7, v5, v7
    v_lshlrev_b32 v6, 5, v6
    v_lshlrev_b32 v5, 4, v5
    v_sub_u32 v5, v5, v6
    v_cmp_lt_u32 vcc, 79, v7
    s_nop 1
    v_cndmask_b32 v30, v5, v31, vcc
    s_add_u32 m0, s72, 93184
    s_nop 0
    buffer_load_dwordx4 v30, s[56:59], 0 offen  lds
    v_add_u32 v5, 256, v0
    v_mul_u32_u24 v6, 800, v5
    v_lshrrev_b32 v6, 16, v6
    v_mul_u32_u24 v7, 82, v6
    v_sub_u32 v7, v5, v7
    v_lshlrev_b32 v6, 5, v6
    v_lshlrev_b32 v5, 4, v5
    v_sub_u32 v5, v5, v6
    v_cmp_lt_u32 vcc, 79, v7
    s_nop 1
    v_cndmask_b32 v30, v5, v31, vcc
    s_add_u32 m0, s72, 94208
    s_nop 0
    buffer_load_dwordx4 v30, s[56:59], 0 offen  lds
    v_add_u32 v5, 320, v0
    v_mul_u32_u24 v6, 800, v5
    v_lshrrev_b32 v6, 16, v6
    v_mul_u32_u24 v7, 82, v6
    v_sub_u32 v7, v5, v7
    v_lshlrev_b32 v6, 5, v6
    v_lshlrev_b32 v5, 4, v5
    v_sub_u32 v5, v5, v6
    v_cmp_lt_u32 vcc, 79, v7
    s_nop 1
    v_cndmask_b32 v30, v5, v31, vcc
    s_add_u32 m0, s72, 95232
    s_nop 0
    buffer_load_dwordx4 v30, s[56:59], 0 offen  lds
    v_add_u32 v5, 384, v0
    v_mul_u32_u24 v6, 800, v5
    v_lshrrev_b32 v6, 16, v6
    v_mul_u32_u24 v7, 82, v6
    v_sub_u32 v7, v5, v7
    v_lshlrev_b32 v6, 5, v6
    v_lshlrev_b32 v5, 4, v5
    v_sub_u32 v5, v5, v6
    v_cmp_lt_u32 vcc, 79, v7
    s_nop 1
    v_cndmask_b32 v30, v5, v31, vcc
    s_add_u32 m0, s72, 96256
    s_nop 0
    buffer_load_dwordx4 v30, s[56:59], 0 offen  lds
    v_add_u32 v5, 448, v0
    v_mul_u32_u24 v6, 800, v5
    v_lshrrev_b32 v6, 16, v6
    v_mul_u32_u24 v7, 82, v6
    v_sub_u32 v7, v5, v7
    v_lshlrev_b32 v6, 5, v6
    v_lshlrev_b32 v5, 4, v5
    v_sub_u32 v5, v5, v6
    v_cmp_lt_u32 vcc, 79, v7
    s_nop 1
    v_cndmask_b32 v30, v5, v31, vcc
    s_add_u32 m0, s72, 97280
    s_nop 0
    buffer_load_dwordx4 v30, s[56:59], 0 offen  lds
    v_add_u32 v5, 512, v0
    v_mul_u32_u24 v6, 800, v5
    v_lshrrev_b32 v6, 16, v6
    v_mul_u32_u24 v7, 82, v6
    v_sub_u32 v7, v5, v7
    v_lshlrev_b32 v6, 5, v6
    v_lshlrev_b32 v5, 4, v5
    v_sub_u32 v5, v5, v6
    v_cmp_lt_u32 vcc, 79, v7
    s_nop 1
    v_cndmask_b32 v30, v5, v31, vcc
    s_add_u32 m0, s72, 98304
    s_nop 0
    buffer_load_dwordx4 v30, s[56:59], 0 offen  lds
    v_add_u32 v5, 576, v0
    v_mul_u32_u24 v6, 800, v5
    v_lshrrev_b32 v6, 16, v6
    v_mul_u32_u24 v7, 82, v6
    v_sub_u32 v7, v5, v7
    v_lshlrev_b32 v6, 5, v6
    v_lshlrev_b32 v5, 4, v5
    v_sub_u32 v5, v5, v6
    v_cmp_lt_u32 vcc, 79, v7
    s_nop 1
    v_cndmask_b32 v30, v5, v31, vcc
    s_add_u32 m0, s72, 99328
    s_nop 0
    buffer_load_dwordx4 v30, s[56:59], 0 offen  lds
    v_add_u32 v5, 640, v0
    v_mul_u32_u24 v6, 800, v5
    v_lshrrev_b32 v6, 16, v6
    v_mul_u32_u24 v7, 82, v6
    v_sub_u32 v7, v5, v7
    v_lshlrev_b32 v6, 5, v6
    v_lshlrev_b32 v5, 4, v5
    v_sub_u32 v5, v5, v6
    v_cmp_lt_u32 vcc, 79, v7
    s_nop 1
    v_cndmask_b32 v30, v5, v31, vcc
    s_mov_b64 exec, 0xffff
    s_add_u32 m0, s72, 100352
    s_nop 0
    buffer_load_dwordx4 v30, s[56:59], 0 offen  lds
    s_mov_b64 exec, -1
    v_lshlrev_b32 v15, 6, v10
    v_lshl_add_u32 v15, v11, 3, v15
    v_add_u32 v15, s11, v15
    v_mul_u32_u24 v16, 1312, v10
    v_lshl_add_u32 v16, v11, 3, v16
    v_add_u32 v16, s9, v16
    v_add_u32 v16, 90112, v16
    s_waitcnt lgkmcnt(0)
    s_add_u32 s6, s6, 0x9e3779b9
    s_waitcnt vmcnt(21)
    s_branch L_grchk
GR_22:
    global_load_dwordx2 v[88:89], v32, s[40:41] offset:0 sc1
    global_load_dwordx2 v[90:91], v32, s[40:41] offset:256 sc1
    global_load_dwordx2 v[92:93], v33, s[40:41] offset:0 sc1
    global_load_dwordx2 v[94:95], v8, s[40:41] offset:0 sc1
    global_load_dwordx2 v[96:97], v8, s[40:41] offset:256 sc1
    global_load_dwordx2 v[98:99], v9, s[40:41] offset:0 sc1
    global_load_dwordx2 v[100:101], v21, s[40:41] offset:0 sc1
    global_load_dwordx2 v[102:103], v21, s[40:41] offset:256 sc1
    global_load_dwordx2 v[104:105], v22, s[40:41] offset:0 sc1
    s_waitcnt vmcnt(0)
L_grchk:
    v_xor_b32 v5, s6, v89
    v_bitop3_b32 v5, v5, v91, s6 bitop3:0xf6
    v_bitop3_b32 v5, v5, v93, s6 bitop3:0xf6
    v_bitop3_b32 v5, v5, v95, s6 bitop3:0xf6
    v_bitop3_b32 v5, v5, v97, s6 bitop3:0xf6
    v_bitop3_b32 v5, v5, v99, s6 bitop3:0xf6
    v_bitop3_b32 v5, v5, v101, s6 bitop3:0xf6
    v_bitop3_b32 v5, v5, v103, s6 bitop3:0xf6
    v_bitop3_b32 v5, v5, v105, s6 bitop3:0xf6
    v_cmp_ne_u32 vcc, 0, v5
    s_cbranch_vccz GD_23
    s_add_u32 s67, s67, 1
    s_cmp_gt_u32 s67, 2000000
    s_cbranch_scc1 L_end
    s_sleep 4
    s_branch GR_22
GD_23:
    v_lshlrev_b32 v40, 16, v40
    v_mov_b32 v43, v88
    v_mov_b32 v120, v94
    v_add_f32 v123, 1.0, v100
    v_cvt_pk_bf16_f32 v123, v123, v123
    v_and_b32 v123, s7, v123
    v_lshlrev_b32 v41, 16, v41
    v_mov_b32 v44, v90
    v_mov_b32 v121, v96
    v_add_f32 v124, 1.0, v102
    v_cvt_pk_bf16_f32 v124, v124, v124
    v_and_b32 v124, s7, v124
    v_lshlrev_b32 v42, 16, v42
    v_mov_b32 v45, v92
    v_mov_b32 v122, v98
    v_add_f32 v125, 1.0, v104
    v_cvt_pk_bf16_f32 v125, v125, v125
    v_and_b32 v125, s7, v125
    v_mov_b32 v46, 0
    v_lshlrev_b32 v5, 16, v24
    v_and_b32 v6, s7, v24
    v_add_f32 v46, v46, v5
    v_add_f32 v46, v46, v6
    v_lshlrev_b32 v5, 16, v25
    v_and_b32 v6, s7, v25
    v_add_f32 v46, v46, v5
    v_add_f32 v46, v46, v6
    v_lshlrev_b32 v5, 16, v26
    v_and_b32 v6, s7, v26
    v_add_f32 v46, v46, v5
    v_add_f32 v46, v46, v6
    v_lshlrev_b32 v5, 16, v27
    v_and_b32 v6, s7, v27
    v_add_f32 v46, v46, v5
    v_add_f32 v46, v46, v6
    v_lshlrev_b32 v5, 16, v28
    v_and_b32 v6, s7, v28
    v_add_f32 v46, v46, v5
    v_add_f32 v46, v46, v6
    s_nop 1
    v_add_f32_dpp v46, v46, v46 quad_perm:[1,0,3,2] row_mask:0xf bank_mask:0xf
    s_nop 1
    v_add_f32_dpp v46, v46, v46 quad_perm:[2,3,0,1] row_mask:0xf bank_mask:0xf
    s_nop 1
    v_add_f32_dpp v46, v46, v46 row_half_mirror row_mask:0xf bank_mask:0xf
    s_nop 1
    v_add_f32_dpp v46, v46, v46 row_mirror row_mask:0xf bank_mask:0xf
    v_mov_b32 v5, v46
    s_nop 1
    v_permlane16_swap_b32 v46, v5
    v_add_f32 v46, v46, v5
    v_mov_b32 v5, v46
    s_nop 1
    v_permlane32_swap_b32 v46, v5
    v_add_f32 v46, v46, v5
    v_mul_f32 v46, 0x3acccccd, v46
    v_mul_u32_u24 v21, 10240, v2
    v_lshl_add_u32 v21, v3, 3, v21
    s_mul_i32 s8, s3, 640
    s_add_u32 s9, s8, 1433600
    v_add_u32 v21, s9, v21
    s_mul_i32 s9, s66, 2560
    s_add_u32 s8, s8, s9
    s_add_u32 s8, s8, 1310720
    v_lshl_add_u32 v22, v0, 2, s8
    s_mul_i32 s8, s3, 320
    v_lshl_add_u32 v23, v2, 4, s8
    s_lshl_b32 s8, s3, 7
    v_add_u32 v47, s8, v13
    s_lshl_b32 s8, s3, 3
    v_mov_b32 v9, s8
    s_lshl_b32 s8, s3, 6
    v_lshrrev_b32 v12, 1, v13
    v_add_u32 v12, s8, v12
    s_add_u32 s8, s8, 2560
    v_lshl_add_u32 v5, v2, 4, s8
    v_lshrrev_b32 v6, 2, v3
    v_mov_b32 v7, 528
    v_cmp_eq_u32 vcc, 0, v6
    s_nop 1
    v_cndmask_b32 v2, v7, v5, vcc
    v_cmp_eq_u32 vcc, 1, v6
    s_nop 1
    v_cndmask_b32 v3, v7, v5, vcc
    v_cmp_eq_u32 vcc, 2, v6
    s_nop 1
    v_cndmask_b32 v10, v7, v5, vcc
    v_cmp_eq_u32 vcc, 3, v6
    s_nop 1
    v_cndmask_b32 v11, v7, v5, vcc
    v_add_u32 v14, 5120, v21
    s_mov_b32 s73, 0
    s_setprio 2
    global_load_dwordx2 v[88:89], v21, s[40:41] offset:0 sc1
    global_load_dwordx2 v[96:97], v21, s[40:41] offset:128 sc1
    global_load_dwordx2 v[104:105], v21, s[40:41] offset:256 sc1
    global_load_dwordx2 v[112:113], v21, s[40:41] offset:384 sc1
    global_load_dwordx2 v[32:33], v21, s[40:41] offset:512 sc1
    global_load_dwordx2 v[90:91], v21, s[40:41] offset:2560 sc1
    global_load_dwordx2 v[98:99], v21, s[40:41] offset:2688 sc1
    global_load_dwordx2 v[106:107], v21, s[40:41] offset:2816 sc1
    global_load_dwordx2 v[114:115], v21, s[40:41] offset:2944 sc1
    global_load_dwordx2 v[34:35], v21, s[40:41] offset:3072 sc1
    global_load_dwordx2 v[92:93], v14, s[40:41] offset:0 sc1
    global_load_dwordx2 v[100:101], v14, s[40:41] offset:128 sc1
    global_load_dwordx2 v[108:109], v14, s[40:41] offset:256 sc1
    global_load_dwordx2 v[116:117], v14, s[40:41] offset:384 sc1
    global_load_dwordx2 v[36:37], v14, s[40:41] offset:512 sc1
    global_load_dwordx2 v[94:95], v14, s[40:41] offset:2560 sc1
    global_load_dwordx2 v[102:103], v14, s[40:41] offset:2688 sc1
    global_load_dwordx2 v[110:111], v14, s[40:41] offset:2816 sc1
    global_load_dwordx2 v[118:119], v14, s[40:41] offset:2944 sc1
    global_load_dwordx2 v[38:39], v14, s[40:41] offset:3072 sc1
    s_waitcnt vmcnt(0)
    ds_read_b64_tr_b16 v[48:49], v15 offset:16384
    ds_read_b64_tr_b16 v[50:51], v15 offset:16640
    ds_read_b64_tr_b16 v[52:53], v15 offset:16416
    ds_read_b64_tr_b16 v[54:55], v15 offset:16672
    ds_read_b64_tr_b16 v[56:57], v15 offset:18432
    ds_read_b64_tr_b16 v[58:59], v15 offset:18688
    ds_read_b64_tr_b16 v[60:61], v15 offset:18464
    ds_read_b64_tr_b16 v[62:63], v15 offset:18720
    ds_read_b64_tr_b16 v[64:65], v15 offset:20480
    ds_read_b64_tr_b16 v[66:67], v15 offset:20736
    ds_read_b64_tr_b16 v[68:69], v15 offset:20512
    ds_read_b64_tr_b16 v[70:71], v15 offset:20768
    ds_read_b64_tr_b16 v[72:73], v15 offset:22528
    ds_read_b64_tr_b16 v[74:75], v15 offset:22784
    ds_read_b64_tr_b16 v[76:77], v15 offset:22560
    ds_read_b64_tr_b16 v[78:79], v15 offset:22816
    ds_read_b64_tr_b16 v[80:81], v15 offset:24576
    ds_read_b64_tr_b16 v[82:83], v15 offset:24832
    ds_read_b64_tr_b16 v[84:85], v15 offset:24608
    ds_read_b64_tr_b16 v[86:87], v15 offset:24864
    s_branch L_g4sum
G4R_25:
    v_max3_u32 v6, v88, v89, v96
    v_max3_u32 v6, v6, v97, v104
    v_max3_u32 v6, v6, v105, v112
    v_max3_u32 v6, v6, v113, v32
    v_max_u32 v6, v6, v33
    v_cmp_eq_u32 s[84:85], -1, v6
    v_max3_u32 v7, v90, v91, v98
    v_max3_u32 v7, v7, v99, v106
    v_max3_u32 v7, v7, v107, v114
    v_max3_u32 v7, v7, v115, v34
    v_max_u32 v7, v7, v35
    v_cmp_eq_u32 s[86:87], -1, v7
    v_max3_u32 v6, v92, v93, v100
    v_max3_u32 v6, v6, v101, v108
    v_max3_u32 v6, v6, v109, v116
    v_max3_u32 v6, v6, v117, v36
    v_max_u32 v6, v6, v37
    v_cmp_eq_u32 s[88:89], -1, v6
    v_max3_u32 v7, v94, v95, v102
    v_max3_u32 v7, v7, v103, v110
    v_max3_u32 v7, v7, v111, v118
    v_max3_u32 v7, v7, v119, v38
    v_max_u32 v7, v7, v39
    v_cmp_eq_u32 s[90:91], -1, v7
    s_or_b64 s[68:69], s[84:85], s[86:87]
    s_or_b64 s[70:71], s[88:89], s[90:91]
    s_or_b64 s[68:69], s[68:69], s[70:71]
    s_cbranch_scc0 L_g4nan
    s_add_u32 s67, s67, 1
    s_cmp_gt_u32 s67, 2000000
    s_cbranch_scc1 L_end
    s_cmp_lg_u32 s73, 0
    s_cbranch_scc1 G4_24
    s_mov_b32 s73, 1
    v_mov_b32 v6, 0
LW_26:
    ds_read_b32 v7, v6 offset:520
    s_waitcnt lgkmcnt(0)
    v_readfirstlane_b32 s8, v7
    s_nop 0
    s_cmp_ge_u32 s8, 11
    s_cbranch_scc1 G4_24
    s_add_u32 s67, s67, 1
    s_cmp_gt_u32 s67, 16000000
    s_cbranch_scc1 L_end
    s_sleep 1
    s_branch LW_26
G4_24:
    s_mov_b64 exec, s[84:85]
    s_cbranch_execz L_g4s0
    global_load_dwordx2 v[88:89], v21, s[40:41] offset:0 sc1
    global_load_dwordx2 v[96:97], v21, s[40:41] offset:128 sc1
    global_load_dwordx2 v[104:105], v21, s[40:41] offset:256 sc1
    global_load_dwordx2 v[112:113], v21, s[40:41] offset:384 sc1
    global_load_dwordx2 v[32:33], v21, s[40:41] offset:512 sc1
L_g4s0:
    s_mov_b64 exec, s[86:87]
    s_cbranch_execz L_g4s1
    global_load_dwordx2 v[90:91], v21, s[40:41] offset:2560 sc1
    global_load_dwordx2 v[98:99], v21, s[40:41] offset:2688 sc1
    global_load_dwordx2 v[106:107], v21, s[40:41] offset:2816 sc1
    global_load_dwordx2 v[114:115], v21, s[40:41] offset:2944 sc1
    global_load_dwordx2 v[34:35], v21, s[40:41] offset:3072 sc1
L_g4s1:
    s_mov_b64 exec, s[88:89]
    s_cbranch_execz L_g4s2
    global_load_dwordx2 v[92:93], v14, s[40:41] offset:0 sc1
    global_load_dwordx2 v[100:101], v14, s[40:41] offset:128 sc1
    global_load_dwordx2 v[108:109], v14, s[40:41] offset:256 sc1
    global_load_dwordx2 v[116:117], v14, s[40:41] offset:384 sc1
    global_load_dwordx2 v[36:37], v14, s[40:41] offset:512 sc1
L_g4s2:
    s_mov_b64 exec, s[90:91]
    s_cbranch_execz L_g4s3
    global_load_dwordx2 v[94:95], v14, s[40:41] offset:2560 sc1
    global_load_dwordx2 v[102:103], v14, s[40:41] offset:2688 sc1
    global_load_dwordx2 v[110:111], v14, s[40:41] offset:2816 sc1
    global_load_dwordx2 v[118:119], v14, s[40:41] offset:2944 sc1
    global_load_dwordx2 v[38:39], v14, s[40:41] offset:3072 sc1
L_g4s3:
    s_mov_b64 exec, -1
    s_waitcnt vmcnt(0)
L_g4sum:
    v_pk_add_f32 v[24:25], v[88:89], v[90:91]
    v_pk_add_f32 v[28:29], v[96:97], v[98:99]
    v_pk_add_f32 v[26:27], v[104:105], v[106:107]
    v_pk_add_f32 v[30:31], v[112:113], v[114:115]
    v_pk_add_f32 v[4:5], v[32:33], v[34:35]
    v_pk_add_f32 v[24:25], v[24:25], v[92:93]
    v_pk_add_f32 v[28:29], v[28:29], v[100:101]
    v_pk_add_f32 v[26:27], v[26:27], v[108:109]
    v_pk_add_f32 v[30:31], v[30:31], v[116:117]
    v_pk_add_f32 v[4:5], v[4:5], v[36:37]
    v_pk_add_f32 v[24:25], v[24:25], v[94:95]
    v_pk_add_f32 v[28:29], v[28:29], v[102:103]
    v_pk_add_f32 v[26:27], v[26:27], v[110:111]
    v_pk_add_f32 v[30:31], v[30:31], v[118:119]
    v_pk_add_f32 v[4:5], v[4:5], v[38:39]
    v_pk_add_f32 v[6:7], v[24:25], v[28:29]
    v_pk_add_f32 v[6:7], v[6:7], v[26:27]
    v_pk_add_f32 v[6:7], v[6:7], v[30:31]
    v_pk_add_f32 v[6:7], v[6:7], v[4:5]
    v_cmp_u_f32 vcc, v6, v7
    s_cbranch_vccnz G4R_25
L_g4nan:
    v_mov_b32 v6, v4
    v_mov_b32 v7, v5
    v_permlane32_swap_b32 v24, v26
    v_permlane32_swap_b32 v25, v27
    v_permlane32_swap_b32 v28, v30
    v_permlane32_swap_b32 v29, v31
    v_permlane32_swap_b32 v4, v6
    v_permlane32_swap_b32 v5, v7
    v_pk_add_f32 v[24:25], v[24:25], v[26:27]
    v_pk_add_f32 v[28:29], v[28:29], v[30:31]
    v_pk_add_f32 v[4:5], v[4:5], v[6:7]
    v_permlane16_swap_b32 v24, v25
    v_permlane16_swap_b32 v28, v29
    v_permlane16_swap_b32 v4, v5
    v_add_f32 v24, v24, v25
    v_add_f32 v28, v28, v29
    v_add_f32 v4, v4, v5
    v_cvt_pk_bf16_f32 v25, v24, v28
    v_cvt_pk_bf16_f32 v4, v4, v4
    v_lshlrev_b32 v24, 16, v25
    v_and_b32 v28, s7, v25
    v_and_b32 v4, s7, v4
    v_mul_f32 v24, v43, v24
    v_mul_f32 v28, v44, v28
    v_mul_f32 v4, v45, v4
    v_cvt_pk_bf16_f32 v25, v24, v28
    v_cvt_pk_bf16_f32 v4, v4, v4
    v_lshlrev_b32 v24, 16, v25
    v_and_b32 v28, s7, v25
    v_and_b32 v4, s7, v4
    v_add_f32 v24, v40, v24
    v_add_f32 v28, v41, v28
    v_add_f32 v4, v42, v4
    v_cvt_pk_bf16_f32 v25, v24, v28
    v_cvt_pk_bf16_f32 v4, v4, v4
    v_lshlrev_b32 v24, 16, v25
    v_and_b32 v28, s7, v25
    v_and_b32 v4, s7, v4
    v_sub_f32 v25, v24, v46
    v_sub_f32 v29, v28, v46
    v_sub_f32 v5, v4, v46
    v_mul_f32 v26, 0.5, v5
    v_add_f32 v30, v25, v29
    v_mul_f32 v31, v25, v25
    v_add_f32 v30, v30, v26
    v_fmac_f32 v31, v29, v29
    v_fmac_f32 v31, v26, v5
    v_add_f32_dpp v30, v30, v30 quad_perm:[1,0,3,2] row_mask:0xf bank_mask:0xf
    s_nop 0
    v_add_f32_dpp v31, v31, v31 quad_perm:[1,0,3,2] row_mask:0xf bank_mask:0xf
    v_add_f32_dpp v30, v30, v30 quad_perm:[2,3,0,1] row_mask:0xf bank_mask:0xf
    s_nop 0
    v_add_f32_dpp v31, v31, v31 quad_perm:[2,3,0,1] row_mask:0xf bank_mask:0xf
    v_add_f32_dpp v30, v30, v30 row_half_mirror row_mask:0xf bank_mask:0xf
    s_nop 0
    v_add_f32_dpp v31, v31, v31 row_half_mirror row_mask:0xf bank_mask:0xf
    v_add_f32_dpp v30, v30, v30 row_mirror row_mask:0xf bank_mask:0xf
    s_nop 0
    v_add_f32_dpp v31, v31, v31 row_mirror row_mask:0xf bank_mask:0xf
    v_mov_b32 v6, v30
    v_mov_b32 v7, v31
    s_nop 0
    v_permlane16_swap_b32 v30, v6
    v_permlane16_swap_b32 v31, v7
    v_add_f32 v30, v30, v6
    v_add_f32 v31, v31, v7
    v_mov_b32 v6, v30
    v_mov_b32 v7, v31
    s_nop 0
    v_permlane32_swap_b32 v30, v6
    v_permlane32_swap_b32 v31, v7
    v_add_f32 v30, v30, v6
    v_add_f32 v31, v31, v7
    ds_write_b64 v9, v[30:31] offset:704
    ds_write_b32 v19, v24 offset:4096
    ds_write_b32 v19, v28 offset:4224
    ds_write_b32 v20, v4 offset:4096
    v_mov_b32 v8, 0
    s_waitcnt vmcnt(0) lgkmcnt(0)
    s_barrier
    ds_read_b128 v[32:35], v8 offset:704
    ds_read_b128 v[36:39], v8 offset:720
    s_waitcnt lgkmcnt(0)
    v_pk_add_f32 v[32:33], v[32:33], v[34:35]
    v_pk_add_f32 v[36:37], v[36:37], v[38:39]
    v_pk_add_f32 v[32:33], v[32:33], v[36:37]
    v_mul_f32 v32, 0x3acccccd, v32
    v_mul_f32 v33, 0x3acccccd, v33
    v_fma_f32 v33, -v32, v32, v33
    v_add_f32 v32, v32, v46
    v_max_f32 v33, 0, v33
    v_cvt_pk_bf16_f32 v34, v32, v33
    v_and_b32 v33, s7, v34
    v_lshlrev_b32 v32, 16, v34
    v_add_f32 v33, 0x3727c5ac, v33
    v_sub_f32 v24, v24, v32
    v_sub_f32 v28, v28, v32
    v_sub_f32 v4, v4, v32
    v_cvt_pk_bf16_f32 v33, v33, v33
    v_and_b32 v33, s7, v33
    v_sqrt_f32 v33, v33
    v_cvt_pk_bf16_f32 v25, v24, v28
    v_cvt_pk_bf16_f32 v4, v4, v4
    v_lshlrev_b32 v24, 16, v25
    v_and_b32 v28, s7, v25
    v_and_b32 v4, s7, v4
    v_cvt_pk_bf16_f32 v33, v33, v33
    v_and_b32 v33, s7, v33
    v_rcp_f32 v33, v33
    s_nop 0
    v_mul_f32 v24, v24, v33
    v_mul_f32 v28, v28, v33
    v_mul_f32 v4, v4, v33
    v_cvt_pk_bf16_f32 v25, v24, v28
    v_cvt_pk_bf16_f32 v4, v4, v4
    v_lshlrev_b32 v24, 16, v25
    v_and_b32 v28, s7, v25
    v_and_b32 v4, s7, v4
    v_mul_f32 v24, v24, v123
    v_mul_f32 v28, v28, v124
    v_mul_f32 v4, v4, v125
    v_cvt_pk_bf16_f32 v25, v24, v28
    v_cvt_pk_bf16_f32 v4, v4, v4
    v_lshlrev_b32 v24, 16, v25
    v_and_b32 v28, s7, v25
    v_and_b32 v4, s7, v4
    v_add_f32 v24, v24, v120
    v_add_f32 v28, v28, v121
    v_add_f32 v4, v4, v122
    v_cvt_pk_bf16_f32 v24, v24, v24
    v_cvt_pk_bf16_f32 v28, v28, v28
    v_cvt_pk_bf16_f32 v4, v4, v4
    ds_write_b16 v17, v24 offset:1024
    ds_write_b16 v17, v28 offset:1088
    ds_write_b16 v18, v4 offset:1024
    ds_read_b128 v[24:27], v23 offset:1024
    ds_read_b128 v[28:31], v23 offset:1088
    ds_read_b128 v[32:35], v23 offset:1152
    ds_read_b128 v[36:39], v23 offset:1216
    ds_read_b128 v[40:43], v23 offset:1280
    s_waitcnt lgkmcnt(4)
    v_mfma_f32_16x16x32_bf16 v[4:7], v[24:27], v[48:51], 0
    ds_read_b64_tr_b16 v[88:89], v16 offset:0
    ds_read_b64_tr_b16 v[90:91], v16 offset:5248
    v_mfma_f32_16x16x32_bf16 v[120:123], v[24:27], v[52:55], 0
    ds_read_b64_tr_b16 v[92:93], v16 offset:32
    ds_read_b64_tr_b16 v[94:95], v16 offset:5280
    s_waitcnt lgkmcnt(7)
    v_mfma_f32_16x16x32_bf16 v[4:7], v[28:31], v[56:59], v[4:7]
    ds_read_b64_tr_b16 v[96:97], v16 offset:64
    ds_read_b64_tr_b16 v[98:99], v16 offset:5312
    v_mfma_f32_16x16x32_bf16 v[120:123], v[28:31], v[60:63], v[120:123]
    ds_read_b64_tr_b16 v[100:101], v16 offset:96
    ds_read_b64_tr_b16 v[102:103], v16 offset:5344
    s_waitcnt lgkmcnt(10)
    v_mfma_f32_16x16x32_bf16 v[4:7], v[32:35], v[64:67], v[4:7]
    ds_read_b64_tr_b16 v[104:105], v16 offset:128
    ds_read_b64_tr_b16 v[106:107], v16 offset:5376
    v_mfma_f32_16x16x32_bf16 v[120:123], v[32:35], v[68:71], v[120:123]
    ds_read_b64_tr_b16 v[108:109], v16 offset:160
    ds_read_b64_tr_b16 v[110:111], v16 offset:5408
    s_waitcnt lgkmcnt(13)
    v_mfma_f32_16x16x32_bf16 v[4:7], v[36:39], v[72:75], v[4:7]
    ds_read_b64_tr_b16 v[112:113], v16 offset:192
    ds_read_b64_tr_b16 v[114:115], v16 offset:5440
    v_mfma_f32_16x16x32_bf16 v[120:123], v[36:39], v[76:79], v[120:123]
    ds_read_b64_tr_b16 v[116:117], v16 offset:224
    ds_read_b64_tr_b16 v[118:119], v16 offset:5472
    s_waitcnt lgkmcnt(15)
    v_mfma_f32_16x16x32_bf16 v[4:7], v[40:43], v[80:83], v[4:7]
    ds_read_b64_tr_b16 v[24:25], v16 offset:256
    ds_read_b64_tr_b16 v[26:27], v16 offset:5504
    v_mfma_f32_16x16x32_bf16 v[120:123], v[40:43], v[84:87], v[120:123]
    ds_read_b64_tr_b16 v[28:29], v16 offset:288
    ds_read_b64_tr_b16 v[30:31], v16 offset:5536
    s_nop 5
    v_cndmask_b32 v8, v4, v120, s[14:15]
    ds_write_b32 v47, v8 offset:3072
    s_waitcnt lgkmcnt(0)
    s_barrier
    ds_read_b32 v32, v13 offset:3072
    ds_read_b32 v33, v13 offset:3200
    ds_read_b32 v34, v13 offset:3328
    ds_read_b32 v35, v13 offset:3456
    s_waitcnt lgkmcnt(2)
    v_add_f32 v32, v32, v33
    s_waitcnt lgkmcnt(0)
    v_add_f32 v34, v34, v35
    v_add_f32 v32, v32, v34
    v_cvt_pk_bf16_f32 v32, v32, v32
    v_and_b32 v32, s7, v32
    v_mul_f32 v33, s42, v32
    v_exp_f32 v33, -v33
    s_nop 0
    v_add_f32 v33, 1.0, v33
    v_rcp_f32 v33, v33
    s_nop 0
    v_mul_f32 v32, v32, v33
    v_cvt_pk_bf16_f32 v32, v32, v32
    ds_write_b16 v12, v32 offset:2560
    ds_read_b128 v[48:51], v2
    ds_read_b128 v[52:55], v3
    ds_read_b128 v[56:59], v10
    ds_read_b128 v[60:63], v11
    s_waitcnt lgkmcnt(3)
    v_mfma_f32_16x16x32_bf16 v[64:67], v[48:51], v[88:91], 0
    v_mfma_f32_16x16x32_bf16 v[68:71], v[48:51], v[104:107], 0
    v_mfma_f32_16x16x32_bf16 v[72:75], v[48:51], v[24:27], 0
    s_waitcnt lgkmcnt(2)
    v_mfma_f32_16x16x32_bf16 v[64:67], v[52:55], v[92:95], v[64:67]
    v_mfma_f32_16x16x32_bf16 v[68:71], v[52:55], v[108:111], v[68:71]
    v_mfma_f32_16x16x32_bf16 v[72:75], v[52:55], v[28:31], v[72:75]
    s_waitcnt lgkmcnt(1)
    v_mfma_f32_16x16x32_bf16 v[64:67], v[56:59], v[96:99], v[64:67]
    v_mfma_f32_16x16x32_bf16 v[68:71], v[56:59], v[112:115], v[68:71]
    s_waitcnt lgkmcnt(0)
    v_mfma_f32_16x16x32_bf16 v[64:67], v[60:63], v[100:103], v[64:67]
    v_mfma_f32_16x16x32_bf16 v[68:71], v[60:63], v[116:119], v[68:71]
    s_nop 1
    v_min_u32 v76, -2, v72
    s_mov_b32 exec_hi, 0
    global_store_dword v22, v76, s[40:41] offset:512 sc1
    s_mov_b64 exec, -1
    s_nop 0
    v_min_u32 v77, -2, v64
    v_min_u32 v78, -2, v68
    global_store_dword v22, v77, s[40:41] sc1
    global_store_dword v22, v78, s[40:41] offset:256 sc1
    s_branch L_end
L_fwave:
LW_27:
    ds_read_b32 v5, v52 offset:524
    s_waitcnt lgkmcnt(0)
    v_readfirstlane_b32 s8, v5
    s_nop 0
    s_cmp_ge_u32 s8, 1
    s_cbranch_scc1 L_frole
    s_add_u32 s67, s67, 1
    s_cmp_gt_u32 s67, 16000000
    s_cbranch_scc1 L_end
    s_sleep 4
    s_branch LW_27
L_frole:
    s_sub_u32 s66, s8, 1
    s_cmp_ge_u32 s66, 40
    s_cbranch_scc1 L_end
    v_and_b32 v4, 3, v0
    v_lshrrev_b32 v5, 4, v0
    v_lshl_add_u32 v6, v4, 2, v5
    s_lshl_b32 s8, s66, 4
    v_add_u32 v6, s8, v6
    v_lshlrev_b32 v7, 3, v6
    v_add_u32 v7, 91136, v7
    s_waitcnt lgkmcnt(0)
    s_add_u32 s6, s6, 0x9e3779b9
GF_28:
    global_load_dwordx2 v[50:51], v7, s[40:41] sc1
    s_waitcnt vmcnt(0)
    v_cmp_ne_u32 vcc, s6, v51
    s_cbranch_vccz GD_29
    s_add_u32 s67, s67, 1
    s_cmp_gt_u32 s67, 2000000
    s_cbranch_scc1 L_end
    s_sleep 4
    s_branch GF_28
GD_29:
    v_lshlrev_b32 v8, 2, v6
    v_lshrrev_b32 v7, 2, v0
    v_mul_u32_u24 v7, 2560, v7
    v_lshl_add_u32 v7, v4, 4, v7
    s_lshl_b32 s8, s66, 6
    s_add_u32 s8, s8, 1310720
    v_add_u32 v7, s8, v7
    v_add_u32 v52, 40960, v7
    v_add_u32 v53, 81920, v7
    v_lshlrev_b32 v6, 1, v6
    v_mov_b32 v4, 0
    v_mov_b32 v5, s6
    v_mov_b32 v24, -1
    v_mov_b32 v25, -1
    v_mov_b32 v26, -1
    v_mov_b32 v27, -1
    v_mov_b32 v28, -1
    v_mov_b32 v29, -1
    v_mov_b32 v30, -1
    v_mov_b32 v31, -1
    v_mov_b32 v32, -1
    v_mov_b32 v33, -1
    v_mov_b32 v34, -1
    v_mov_b32 v35, -1
    s_barrier
    ds_read_b32 v48, v8 offset:4096
    s_waitcnt lgkmcnt(0)
    s_barrier
    s_mov_b64 s[68:69], -1
G5_30:
    s_mov_b64 exec, s[68:69]
    global_load_dwordx4 v[24:27], v7, s[40:41] sc1
    global_load_dwordx4 v[28:31], v52, s[40:41] sc1
    global_load_dwordx4 v[32:35], v53, s[40:41] sc1
    s_mov_b64 exec, -1
    s_waitcnt vmcnt(3)
    v_pk_add_f32 v[36:37], v[24:25], v[28:29]
    v_pk_add_f32 v[38:39], v[26:27], v[30:31]
    v_pk_add_f32 v[36:37], v[36:37], v[32:33]
    v_pk_add_f32 v[38:39], v[38:39], v[34:35]
    v_pk_add_f32 v[42:43], v[36:37], v[38:39]
    v_cmp_u_f32 vcc, v42, v43
    s_cbranch_vccz NR_31
    s_mov_b64 s[68:69], vcc
    s_add_u32 s67, s67, 1
    s_and_b32 s8, s67, 15
    s_cbranch_scc1 G5_30
    s_cmp_gt_u32 s67, 2000000
    s_cbranch_scc1 L_end
    s_cmp_eq_u32 s63, 1
    s_cbranch_scc1 NR_31
    v_mov_b32 v40, v24
    v_max3_u32 v40, v40, v25, v26
    v_max3_u32 v40, v40, v27, v28
    v_max3_u32 v40, v40, v29, v30
    v_max3_u32 v40, v40, v31, v32
    v_max3_u32 v40, v40, v33, v34
    v_max_u32 v40, v40, v35
    v_cmp_eq_u32 vcc, -1, v40
    s_cbranch_vccnz G5_30
    s_mov_b32 s63, 1
    s_branch G5_30
NR_31:
    v_permlane32_swap_b32 v36, v38
    v_permlane32_swap_b32 v37, v39
    v_add_f32 v36, v36, v38
    v_add_f32 v37, v37, v39
    s_nop 1
    v_permlane16_swap_b32 v36, v37
    v_add_f32 v36, v36, v37
    s_nop 1
    v_add_f32_dpp v36, v36, v36 row_ror:8 row_mask:0xf bank_mask:0xf
    s_nop 1
    v_add_f32_dpp v36, v36, v36 row_ror:4 row_mask:0xf bank_mask:0xf
    v_cvt_pk_bf16_f32 v36, v36, v36
    v_and_b32 v36, s7, v36
    v_mul_f32 v36, v50, v36
    v_cvt_pk_bf16_f32 v36, v36, v36
    v_and_b32 v36, s7, v36
    v_add_f32 v36, v48, v36
    v_cvt_pk_bf16_f32 v36, v36, v36
    s_mov_b32 exec_lo, 0x000f000f
    s_mov_b32 exec_hi, 0x000f000f
    global_store_short v6, v36, s[36:37]
    s_cmp_lg_u32 s66, 0
    s_cbranch_scc1 L_fend
    s_mov_b64 exec, 1
    global_store_dword v4, v5, s[40:41] sc1
L_fend:
    s_mov_b64 exec, -1
L_end:
L_exit:
    s_endpgm
.section .rodata,"a"
.p2align 6
.amdhsa_kernel adaLN_cond__gqa_block_cached__dense_activation_silu__decode_kernel
  .amdhsa_next_free_vgpr 128
  .amdhsa_next_free_sgpr 102
  .amdhsa_accum_offset 128
  .amdhsa_group_segment_fixed_size 0
  .amdhsa_kernarg_size 104
  .amdhsa_user_sgpr_count 2
  .amdhsa_user_sgpr_kernarg_segment_ptr 1
  .amdhsa_system_sgpr_workgroup_id_x 1
  .amdhsa_float_denorm_mode_32 3
.end_amdhsa_kernel
```
